```python
import torch

def _softmax(x, axis=-1):
    return torch.softmax(x, dim=axis)

def _gelu(x):
    return torch.nn.functional.gelu(x, approximate='tanh')

def _silu(x):
    return torch.nn.functional.silu(x)

def _sigmoid(x):
    return torch.sigmoid(x)

def _layernorm(x, axis=-1, eps=1e-05):
    m = x.mean(dim=axis, keepdim=True)
    v = x.var(dim=axis, keepdim=True, unbiased=False)
    return (x - m) / torch.sqrt(v + eps)

def _scatter_add(tgt, idx, src, axis=0):
    return tgt.clone().index_add_(axis, idx, src)

def _segment_sum(src, seg, n):
    out = torch.zeros((n,) + src.shape[1:], dtype=src.dtype)
    return out.index_add_(0, seg, src)

def _pad(x, pw):
    flat = tuple((v for pair in reversed(pw) for v in pair))
    return torch.nn.functional.pad(x, flat)
kernel_name = 'sequential_preLN__memory_aug_recurrent_mem_tr__swiglu_ffn__prompt'

def setup_inputs():

    _w = lambda a: (lambda t: t.to(torch.bfloat16) if t.is_floating_point() else t)(torch.as_tensor(a))

    def _A_setup():
        B, S, Dm = (1, 2048, 640)
        H, Dh = (32, 128)
        M, seg = (8, 32)
        seg = min(seg, S)
        S = S // seg * seg
        return {'x': _w((lambda *s: torch.randn(*s, dtype=torch.bfloat16) * 0.05)(B, S, Dm)), 'mem0': _w((lambda *s: torch.randn(*s, dtype=torch.bfloat16) * 0.2)(B, M, Dm)), 'Wq': _w((lambda *s: torch.randn(*s, dtype=torch.bfloat16) * 1.6)(Dm, H, Dh) * Dm ** (-0.5)), 'Wk': _w((lambda *s: torch.randn(*s, dtype=torch.bfloat16) * 1.6)(Dm, H, Dh) * Dm ** (-0.5)), 'Wv': _w((lambda *s: torch.randn(*s, dtype=torch.bfloat16) * 0.2)(Dm, H, Dh) * Dm ** (-0.5)), 'Wo': _w((lambda *s: torch.randn(*s, dtype=torch.bfloat16) * 0.2)(H, Dh, Dm) * (H * Dh) ** (-0.5)), 'seg_len': seg}
    _A_in = _A_setup()

    def _B_setup():
        B, S, D, F = (1, 2048, 640, 1728)
        return {'x': _w((lambda *s: torch.randn(*s, dtype=torch.bfloat16) * 0.05)(B, S, D)), 'w_gate': _w((lambda *s: torch.randn(*s, dtype=torch.bfloat16) * 0.05)(D, F)), 'w_up': _w((lambda *s: torch.randn(*s, dtype=torch.bfloat16) * 0.05)(D, F)), 'w_down': _w((lambda *s: torch.randn(*s, dtype=torch.bfloat16) * 0.05)(F, D))}
    _B_in = _B_setup()
    return {'A_x': _A_in['x'], 'A_mem0': _A_in['mem0'], 'A_Wq': _A_in['Wq'], 'A_Wk': _A_in['Wk'], 'A_Wv': _A_in['Wv'], 'A_Wo': _A_in['Wo'], 'A_seg_len': _A_in['seg_len'], 'B_x': _B_in['x'], 'B_w_gate': _B_in['w_gate'], 'B_w_up': _B_in['w_up'], 'B_w_down': _B_in['w_down']}

def reference(A_x, A_mem0, A_Wq, A_Wk, A_Wv, A_Wo, A_seg_len, B_x, B_w_gate, B_w_up, B_w_down):

    def _A_ref(x, mem0, Wq, Wk, Wv, Wo, seg_len):
        B, S, Dm = x.shape
        H, Dh = (Wq.shape[1], Wq.shape[2])
        M = mem0.shape[1]
        scale = Dh ** (-0.5)
        n_seg = S // seg_len
        L = M + seg_len
        idx = torch.arange(L)
        mask = (idx[:, None] < M) | (idx[:, None] >= idx[None, :])
        mem = mem0
        outs = []
        for s in range(n_seg):
            xs = x[:, s * seg_len:(s + 1) * seg_len, :].clone()
            h = torch.concatenate([mem, xs], axis=1)
            q = torch.einsum('btd,dhe->bhte', h, Wq)
            k = torch.einsum('btd,dhe->bhte', h, Wk)
            v = torch.einsum('btd,dhe->bhte', h, Wv)
            scores = torch.einsum('bhqe,bhke->bhqk', q, k) * scale
            scores = torch.where(mask[None, None], scores, -1000000000.0)
            p = _softmax(scores, axis=-1)
            o = torch.einsum('bhqk,bhke->bhqe', p, v)
            o = torch.einsum('bhte,hed->btd', o, Wo)
            mem = o[:, :M, :].clone()
            outs.append(o[:, M:, :])
        return torch.concatenate(outs, axis=1)

    def _B_ref(x, w_gate, w_up, w_down):
        g = _silu(x @ w_gate)
        u = x @ w_up
        return g * u @ w_down
    x = A_x
    h = x + _A_ref(_layernorm(x, axis=-1), A_mem0, A_Wq, A_Wk, A_Wv, A_Wo, A_seg_len)
    h2 = h + _B_ref(_layernorm(h, axis=-1), B_w_gate, B_w_up, B_w_down)
    return h2
```

```asm
; @launch kernel=mega_kernel grid=(256,1,1) block=(256,1,1) lds=163840
.amdgcn_target "amdgcn-amd-amdhsa--gfx950"
.text
.globl mega_kernel
.p2align 8
.type mega_kernel,@function
mega_kernel:
    s_cmp_ge_u32 s2, 256
    s_cbranch_scc1 Lendf_3
    s_load_dwordx2 s[4:5], s[0:1], 104
    s_load_dwordx2 s[6:7], s[0:1], 96
    s_getreg_b32 s3, hwreg(HW_REG_XCC_ID)
    s_and_b32 s3, s3, 15
    v_lshrrev_b32 v3, 6, v0
    s_nop 0
    v_readfirstlane_b32 s10, v3
    s_waitcnt lgkmcnt(0)
    s_cmp_lg_u32 s10, 0
    s_cbranch_scc1 Lrw_4
    s_lshl_b32 s12, s3, 2
    v_mov_b32 v4, s12
    v_mov_b32 v5, 1
    s_mov_b64 exec, 1
    global_atomic_add v6, v4, v5, s[6:7] sc0
    s_waitcnt vmcnt(0)
    v_readfirstlane_b32 s11, v6
    s_nop 3
    s_mov_b32 s13, -1
    s_cmp_ge_u32 s11, 32
    s_cbranch_scc1 Lwd_6
    s_cmp_lg_u32 s11, 31
    s_cbranch_scc1 Lwp_5
    s_cmp_lg_u32 s3, 0
    s_cbranch_scc1 Lwp_5
    s_add_u32 s12, s3, 1
    v_mov_b32 v4, 32
    v_mov_b32 v6, s12
    v_mov_b32 v7, 0
    global_atomic_cmpswap v4, v[6:7], s[6:7]
    s_waitcnt vmcnt(0)
Lwp_5:
    s_mov_b32 s14, 4000000
Lwp2_7:
    s_cmp_lg_u32 s14, 3998000
    s_cbranch_scc1 Lwnc_8
    s_cmp_lg_u32 s11, 31
    s_cbranch_scc1 Lwnc_8
    s_add_u32 s12, s3, 1
    v_mov_b32 v4, 32
    v_mov_b32 v6, s12
    v_mov_b32 v7, 0
    global_atomic_cmpswap v4, v[6:7], s[6:7]
    s_waitcnt vmcnt(0)
Lwnc_8:
    v_mov_b32 v4, 32
    global_load_dword v6, v4, s[6:7] sc1
    s_waitcnt vmcnt(0)
    v_readfirstlane_b32 s12, v6
    s_sub_u32 s14, s14, 1
    s_cbranch_scc1 Lwd_6
    s_cmp_eq_u32 s12, 0
    s_cbranch_scc1 Lwp2_7
    s_add_u32 s15, s3, 1
    s_cmp_eq_u32 s12, s15
    s_cselect_b32 s13, s11, -1
Lwd_6:
    v_mov_b32 v4, 0
    v_mov_b32 v6, s13
    ds_write_b32 v4, v6
    s_mov_b64 exec, -1
    s_waitcnt lgkmcnt(0)
Lrw_4:
    s_barrier
    v_mov_b32 v4, 0
    ds_read_b32 v6, v4
    s_waitcnt lgkmcnt(0)
    v_readfirstlane_b32 s11, v6
    s_nop 3
    s_barrier
    s_cmp_ge_u32 s11, 32
    s_cbranch_scc0 Lchain_9
    v_and_b32 v2, 63, v0
    s_mov_b32 s63, 6000000
    s_mov_b32 s96, -1
    s_mov_b32 s97, 0
    s_mov_b32 s59, 0
    s_mov_b32 s57, 0
    v_mov_b32 v20, 32
    global_load_dword v21, v20, s[6:7] sc1
    s_waitcnt vmcnt(0)
    v_readfirstlane_b32 s67, v21
    s_nop 3
    s_mov_b32 s68, s3
    s_cmp_ge_u32 s3, s67
    s_cselect_b32 s69, 1, 0
    s_cmp_eq_u32 s67, 0
    s_cselect_b32 s69, 0, s69
    s_sub_u32 s68, s68, s69
    s_min_u32 s68, s68, 6
    s_mov_b32 s56, s68
    s_mov_b32 s69, 0
    s_load_dwordx2 s[40:41], s[0:1], 0
    v_lshlrev_b32 v3, 4, v2
    v_mov_b32 v100, 0
    v_mov_b32 v101, 0
    v_mov_b32 v102, 0
    v_mov_b32 v103, 0
Llq_12:
    s_lshl_b32 s77, s56, 2
    s_add_u32 s77, s77, 76
    s_cmp_lg_u32 s10, 0
    s_cbranch_scc1 Lnf_15
    s_mov_b64 exec, 1
    v_mov_b32 v20, s77
    v_mov_b32 v21, 1
    global_atomic_add v22, v20, v21, s[6:7] sc0
    s_waitcnt vmcnt(0)
    v_mov_b32 v20, 159744
    ds_write_b32 v20, v22
    s_waitcnt lgkmcnt(0)
    s_mov_b64 exec, -1
Lnf_15:
    s_barrier
    v_mov_b32 v20, 159744
    ds_read_b32 v22, v20
    s_waitcnt lgkmcnt(0)
    v_readfirstlane_b32 s60, v22
    s_nop 3
    s_barrier
    s_mul_i32 s60, s60, 7
    s_add_u32 s60, s60, s56
    s_cmp_lt_u32 s60, 256
    s_cbranch_scc1 Llqg_14
    s_cmp_lg_u32 s10, 0
    s_cbranch_scc1 Lsb_16
    v_lshlrev_b32 v20, 2, v2
    s_mov_b64 exec, 0x7f
    global_load_dword v21, v20, s[6:7] offset:76 sc1
    s_waitcnt vmcnt(0)
    v_mul_u32_u24 v21, 7, v21
    v_add_u32 v21, v21, v2
    v_cmp_gt_u32 vcc, 256, v21
    s_mov_b64 exec, -1
    s_nop 3
    s_and_b32 s56, vcc_lo, 0x7f
    v_mov_b32 v20, 159808
    v_mov_b32 v21, s56
    ds_write_b32 v20, v21
    s_waitcnt lgkmcnt(0)
Lsb_16:
    s_barrier
    v_mov_b32 v20, 159808
    ds_read_b32 v21, v20
    s_waitcnt lgkmcnt(0)
    v_readfirstlane_b32 s56, v21
    s_nop 3
    s_barrier
    s_cmp_eq_u32 s56, 0
    s_cbranch_scc1 Llqd_13
    s_ff1_i32_b32 s56, s56
    s_add_u32 s69, s69, 1
    s_cmp_lt_u32 s69, 64
    s_cbranch_scc1 Llq_12
    s_branch Llqd_13
Llqg_14:
    s_waitcnt lgkmcnt(0)
    s_lshl_b32 s11, s60, 3
    s_lshl_b32 s12, s10, 1
    s_add_u32 s11, s11, s12
    s_mul_i32 s12, s11, 1280
    s_add_u32 s16, s40, s12
    s_addc_u32 s17, s41, 0
    s_add_u32 s18, s4, 0x0
    s_addc_u32 s19, s5, 0
    s_add_u32 s18, s18, s12
    s_addc_u32 s19, s19, 0
    s_add_u32 s20, s16, 1280
    s_addc_u32 s21, s17, 0
    s_add_u32 s22, s18, 1280
    s_addc_u32 s23, s19, 0
    global_load_dwordx4 v[10:13], v3, s[16:17]
    v_mov_b32 v14, 0
    v_mov_b32 v15, 0
    v_mov_b32 v16, 0
    v_mov_b32 v17, 0
    s_mov_b64 exec, 0xffff
    global_load_dwordx4 v[14:17], v3, s[16:17] offset:1024
    s_mov_b64 exec, -1
    global_load_dwordx4 v[50:53], v3, s[20:21]
    v_mov_b32 v54, 0
    v_mov_b32 v55, 0
    v_mov_b32 v56, 0
    v_mov_b32 v57, 0
    s_mov_b64 exec, 0xffff
    global_load_dwordx4 v[54:57], v3, s[20:21] offset:1024
    s_mov_b64 exec, -1
    s_waitcnt vmcnt(0)
    v_lshlrev_b32 v20, 16, v10
    v_and_b32 v21, 0xffff0000, v10
    v_lshlrev_b32 v22, 16, v11
    v_and_b32 v23, 0xffff0000, v11
    v_lshlrev_b32 v24, 16, v12
    v_and_b32 v25, 0xffff0000, v12
    v_lshlrev_b32 v26, 16, v13
    v_and_b32 v27, 0xffff0000, v13
    v_lshlrev_b32 v28, 16, v14
    v_and_b32 v29, 0xffff0000, v14
    v_lshlrev_b32 v30, 16, v15
    v_and_b32 v31, 0xffff0000, v15
    v_lshlrev_b32 v32, 16, v16
    v_and_b32 v33, 0xffff0000, v16
    v_lshlrev_b32 v34, 16, v17
    v_and_b32 v35, 0xffff0000, v17
    v_add_f32 v36, v20, v21
    v_add_f32 v36, v36, v22
    v_add_f32 v36, v36, v23
    v_add_f32 v36, v36, v24
    v_add_f32 v36, v36, v25
    v_add_f32 v36, v36, v26
    v_add_f32 v36, v36, v27
    v_add_f32 v36, v36, v28
    v_add_f32 v36, v36, v29
    v_add_f32 v36, v36, v30
    v_add_f32 v36, v36, v31
    v_add_f32 v36, v36, v32
    v_add_f32 v36, v36, v33
    v_add_f32 v36, v36, v34
    v_add_f32 v36, v36, v35
    s_nop 1
    v_add_f32_dpp v36, v36, v36 quad_perm:[1,0,3,2] row_mask:0xf bank_mask:0xf
    s_nop 1
    v_add_f32_dpp v36, v36, v36 quad_perm:[2,3,0,1] row_mask:0xf bank_mask:0xf
    s_nop 1
    v_add_f32_dpp v36, v36, v36 row_half_mirror row_mask:0xf bank_mask:0xf
    s_nop 1
    v_add_f32_dpp v36, v36, v36 row_mirror row_mask:0xf bank_mask:0xf
    v_mov_b32 v37, v36
    s_nop 1
    v_permlane16_swap_b32 v36, v37
    v_add_f32 v36, v36, v37
    v_mov_b32 v37, v36
    s_nop 1
    v_permlane32_swap_b32 v36, v37
    v_add_f32 v36, v36, v37
    v_mul_f32 v36, 0x3acccccd, v36
    v_sub_f32 v20, v20, v36
    v_sub_f32 v21, v21, v36
    v_sub_f32 v22, v22, v36
    v_sub_f32 v23, v23, v36
    v_sub_f32 v24, v24, v36
    v_sub_f32 v25, v25, v36
    v_sub_f32 v26, v26, v36
    v_sub_f32 v27, v27, v36
    s_mov_b64 exec, 0xffff
    v_sub_f32 v28, v28, v36
    v_sub_f32 v29, v29, v36
    v_sub_f32 v30, v30, v36
    v_sub_f32 v31, v31, v36
    v_sub_f32 v32, v32, v36
    v_sub_f32 v33, v33, v36
    v_sub_f32 v34, v34, v36
    v_sub_f32 v35, v35, v36
    s_mov_b64 exec, -1
    v_mul_f32 v38, v20, v20
    v_fmac_f32 v38, v21, v21
    v_fmac_f32 v38, v22, v22
    v_fmac_f32 v38, v23, v23
    v_fmac_f32 v38, v24, v24
    v_fmac_f32 v38, v25, v25
    v_fmac_f32 v38, v26, v26
    v_fmac_f32 v38, v27, v27
    v_fmac_f32 v38, v28, v28
    v_fmac_f32 v38, v29, v29
    v_fmac_f32 v38, v30, v30
    v_fmac_f32 v38, v31, v31
    v_fmac_f32 v38, v32, v32
    v_fmac_f32 v38, v33, v33
    v_fmac_f32 v38, v34, v34
    v_fmac_f32 v38, v35, v35
    s_nop 1
    v_add_f32_dpp v38, v38, v38 quad_perm:[1,0,3,2] row_mask:0xf bank_mask:0xf
    s_nop 1
    v_add_f32_dpp v38, v38, v38 quad_perm:[2,3,0,1] row_mask:0xf bank_mask:0xf
    s_nop 1
    v_add_f32_dpp v38, v38, v38 row_half_mirror row_mask:0xf bank_mask:0xf
    s_nop 1
    v_add_f32_dpp v38, v38, v38 row_mirror row_mask:0xf bank_mask:0xf
    v_mov_b32 v37, v38
    s_nop 1
    v_permlane16_swap_b32 v38, v37
    v_add_f32 v38, v38, v37
    v_mov_b32 v37, v38
    s_nop 1
    v_permlane32_swap_b32 v38, v37
    v_add_f32 v38, v38, v37
    v_mov_b32 v39, 0x3727c5ac
    v_fmac_f32 v39, 0x3acccccd, v38
    v_rsq_f32 v39, v39
    s_nop 0
    v_mul_f32 v20, v20, v39
    v_mul_f32 v21, v21, v39
    v_mul_f32 v22, v22, v39
    v_mul_f32 v23, v23, v39
    v_mul_f32 v24, v24, v39
    v_mul_f32 v25, v25, v39
    v_mul_f32 v26, v26, v39
    v_mul_f32 v27, v27, v39
    v_mul_f32 v28, v28, v39
    v_mul_f32 v29, v29, v39
    v_mul_f32 v30, v30, v39
    v_mul_f32 v31, v31, v39
    v_mul_f32 v32, v32, v39
    v_mul_f32 v33, v33, v39
    v_mul_f32 v34, v34, v39
    v_mul_f32 v35, v35, v39
    v_cvt_pk_bf16_f32 v10, v20, v21
    v_cvt_pk_bf16_f32 v11, v22, v23
    v_cvt_pk_bf16_f32 v12, v24, v25
    v_cvt_pk_bf16_f32 v13, v26, v27
    v_cvt_pk_bf16_f32 v14, v28, v29
    v_cvt_pk_bf16_f32 v15, v30, v31
    v_cvt_pk_bf16_f32 v16, v32, v33
    v_cvt_pk_bf16_f32 v17, v34, v35
    global_store_dwordx4 v3, v[10:13], s[18:19] sc1
    s_mov_b64 exec, 0xffff
    global_store_dwordx4 v3, v[14:17], s[18:19] offset:1024 sc1
    s_mov_b64 exec, -1
    v_lshlrev_b32 v60, 16, v50
    v_and_b32 v61, 0xffff0000, v50
    v_lshlrev_b32 v62, 16, v51
    v_and_b32 v63, 0xffff0000, v51
    v_lshlrev_b32 v64, 16, v52
    v_and_b32 v65, 0xffff0000, v52
    v_lshlrev_b32 v66, 16, v53
    v_and_b32 v67, 0xffff0000, v53
    v_lshlrev_b32 v68, 16, v54
    v_and_b32 v69, 0xffff0000, v54
    v_lshlrev_b32 v70, 16, v55
    v_and_b32 v71, 0xffff0000, v55
    v_lshlrev_b32 v72, 16, v56
    v_and_b32 v73, 0xffff0000, v56
    v_lshlrev_b32 v74, 16, v57
    v_and_b32 v75, 0xffff0000, v57
    v_add_f32 v76, v60, v61
    v_add_f32 v76, v76, v62
    v_add_f32 v76, v76, v63
    v_add_f32 v76, v76, v64
    v_add_f32 v76, v76, v65
    v_add_f32 v76, v76, v66
    v_add_f32 v76, v76, v67
    v_add_f32 v76, v76, v68
    v_add_f32 v76, v76, v69
    v_add_f32 v76, v76, v70
    v_add_f32 v76, v76, v71
    v_add_f32 v76, v76, v72
    v_add_f32 v76, v76, v73
    v_add_f32 v76, v76, v74
    v_add_f32 v76, v76, v75
    s_nop 1
    v_add_f32_dpp v76, v76, v76 quad_perm:[1,0,3,2] row_mask:0xf bank_mask:0xf
    s_nop 1
    v_add_f32_dpp v76, v76, v76 quad_perm:[2,3,0,1] row_mask:0xf bank_mask:0xf
    s_nop 1
    v_add_f32_dpp v76, v76, v76 row_half_mirror row_mask:0xf bank_mask:0xf
    s_nop 1
    v_add_f32_dpp v76, v76, v76 row_mirror row_mask:0xf bank_mask:0xf
    v_mov_b32 v77, v76
    s_nop 1
    v_permlane16_swap_b32 v76, v77
    v_add_f32 v76, v76, v77
    v_mov_b32 v77, v76
    s_nop 1
    v_permlane32_swap_b32 v76, v77
    v_add_f32 v76, v76, v77
    v_mul_f32 v76, 0x3acccccd, v76
    v_sub_f32 v60, v60, v76
    v_sub_f32 v61, v61, v76
    v_sub_f32 v62, v62, v76
    v_sub_f32 v63, v63, v76
    v_sub_f32 v64, v64, v76
    v_sub_f32 v65, v65, v76
    v_sub_f32 v66, v66, v76
    v_sub_f32 v67, v67, v76
    s_mov_b64 exec, 0xffff
    v_sub_f32 v68, v68, v76
    v_sub_f32 v69, v69, v76
    v_sub_f32 v70, v70, v76
    v_sub_f32 v71, v71, v76
    v_sub_f32 v72, v72, v76
    v_sub_f32 v73, v73, v76
    v_sub_f32 v74, v74, v76
    v_sub_f32 v75, v75, v76
    s_mov_b64 exec, -1
    v_mul_f32 v78, v60, v60
    v_fmac_f32 v78, v61, v61
    v_fmac_f32 v78, v62, v62
    v_fmac_f32 v78, v63, v63
    v_fmac_f32 v78, v64, v64
    v_fmac_f32 v78, v65, v65
    v_fmac_f32 v78, v66, v66
    v_fmac_f32 v78, v67, v67
    v_fmac_f32 v78, v68, v68
    v_fmac_f32 v78, v69, v69
    v_fmac_f32 v78, v70, v70
    v_fmac_f32 v78, v71, v71
    v_fmac_f32 v78, v72, v72
    v_fmac_f32 v78, v73, v73
    v_fmac_f32 v78, v74, v74
    v_fmac_f32 v78, v75, v75
    s_nop 1
    v_add_f32_dpp v78, v78, v78 quad_perm:[1,0,3,2] row_mask:0xf bank_mask:0xf
    s_nop 1
    v_add_f32_dpp v78, v78, v78 quad_perm:[2,3,0,1] row_mask:0xf bank_mask:0xf
    s_nop 1
    v_add_f32_dpp v78, v78, v78 row_half_mirror row_mask:0xf bank_mask:0xf
    s_nop 1
    v_add_f32_dpp v78, v78, v78 row_mirror row_mask:0xf bank_mask:0xf
    v_mov_b32 v77, v78
    s_nop 1
    v_permlane16_swap_b32 v78, v77
    v_add_f32 v78, v78, v77
    v_mov_b32 v77, v78
    s_nop 1
    v_permlane32_swap_b32 v78, v77
    v_add_f32 v78, v78, v77
    v_mov_b32 v79, 0x3727c5ac
    v_fmac_f32 v79, 0x3acccccd, v78
    v_rsq_f32 v79, v79
    s_nop 0
    v_mul_f32 v60, v60, v79
    v_mul_f32 v61, v61, v79
    v_mul_f32 v62, v62, v79
    v_mul_f32 v63, v63, v79
    v_mul_f32 v64, v64, v79
    v_mul_f32 v65, v65, v79
    v_mul_f32 v66, v66, v79
    v_mul_f32 v67, v67, v79
    v_mul_f32 v68, v68, v79
    v_mul_f32 v69, v69, v79
    v_mul_f32 v70, v70, v79
    v_mul_f32 v71, v71, v79
    v_mul_f32 v72, v72, v79
    v_mul_f32 v73, v73, v79
    v_mul_f32 v74, v74, v79
    v_mul_f32 v75, v75, v79
    v_cvt_pk_bf16_f32 v50, v60, v61
    v_cvt_pk_bf16_f32 v51, v62, v63
    v_cvt_pk_bf16_f32 v52, v64, v65
    v_cvt_pk_bf16_f32 v53, v66, v67
    v_cvt_pk_bf16_f32 v54, v68, v69
    v_cvt_pk_bf16_f32 v55, v70, v71
    v_cvt_pk_bf16_f32 v56, v72, v73
    v_cvt_pk_bf16_f32 v57, v74, v75
    global_store_dwordx4 v3, v[50:53], s[22:23] sc1
    s_mov_b64 exec, 0xffff
    global_store_dwordx4 v3, v[54:57], s[22:23] offset:1024 sc1
    s_mov_b64 exec, -1
    s_cmp_lg_u32 s10, 0
    s_cbranch_scc1 Lz_17
    s_mov_b64 exec, 0xff
    s_and_b32 s12, s60, 3
    s_cmp_lg_u32 s12, 0
    s_cbranch_scc1 Lz2_18
    s_lshl_b32 s12, s60, 5
    s_add_u32 s13, s12, 0x7408000
    v_add_u32 v4, s13, v3
    global_store_dwordx4 v4, v[100:103], s[4:5] sc1
    s_add_u32 s13, s12, 0x7410000
    v_add_u32 v4, s13, v3
    global_store_dwordx4 v4, v[100:103], s[4:5] sc1
Lz2_18:
    s_cmp_ge_u32 s60, 8
    s_cbranch_scc1 Lz3_19
    s_lshl_b32 s12, s60, 7
    s_add_u32 s13, s12, 0x7403000
    v_add_u32 v4, s13, v3
    global_store_dwordx4 v4, v[100:103], s[4:5] sc1
Lz3_19:
    s_mov_b64 exec, -1
Lz_17:
    s_lshr_b32 s13, s60, 4
    s_lshl_b32 s13, s13, 2
    s_add_u32 s13, s13, 128
    s_waitcnt vmcnt(0)
    s_barrier
    s_cmp_lg_u32 s10, 0
    s_cbranch_scc1 Lsg_20
    s_mov_b64 exec, 1
    v_mov_b32 v20, s13
    v_mov_b32 v21, 1
    global_atomic_add v20, v21, s[6:7]
    s_mov_b64 exec, -1
Lsg_20:
    s_branch Llq_12
Llqd_13:
    s_mov_b32 s69, 0
Lw_10:
    s_lshl_b32 s77, s68, 2
    s_add_u32 s77, s77, 44
    s_cmp_lg_u32 s10, 0
    s_cbranch_scc1 Lnf_21
    s_mov_b64 exec, 1
    v_mov_b32 v20, s77
    v_mov_b32 v21, 1
    global_atomic_add v22, v20, v21, s[6:7] sc0
    s_waitcnt vmcnt(0)
    v_mov_b32 v20, 159744
    ds_write_b32 v20, v22
    s_waitcnt lgkmcnt(0)
    s_mov_b64 exec, -1
Lnf_21:
    s_barrier
    v_mov_b32 v20, 159744
    ds_read_b32 v22, v20
    s_waitcnt lgkmcnt(0)
    v_readfirstlane_b32 s60, v22
    s_nop 3
    s_barrier
    s_cmp_lt_u32 s68, 5
    s_cselect_b32 s78, 14, 13
    s_mov_b32 s79, 0x13b13b14
    s_cselect_b32 s79, 0x12492493, s79
    s_lshl_b32 s77, s78, 4
    s_cmp_lt_u32 s60, s77
    s_cbranch_scc1 Lnq_22
    s_add_u32 s68, s68, 1
    s_cmp_eq_u32 s68, 7
    s_cselect_b32 s68, 0, s68
    s_add_u32 s69, s69, 1
    s_cmp_lt_u32 s69, 7
    s_cbranch_scc1 Lw_10
    s_branch Lroles_11
Lnq_22:
    s_mul_hi_u32 s12, s60, s79
    s_mul_i32 s13, s12, s78
    s_sub_u32 s13, s60, s13
    s_mul_i32 s13, s13, 7
    s_add_u32 s13, s13, s68
    s_mul_i32 s60, s12, 96
    s_add_u32 s60, s60, s13
    s_cmp_lt_u32 s12, s59
    s_cbranch_scc1 Llr_23
    s_cmp_lg_u32 s10, 0
    s_cbranch_scc1 Ldw_24
Llp_27:
    v_lshlrev_b32 v20, 2, v2
    s_mov_b64 exec, 0xffff
    global_load_dword v21, v20, s[6:7] offset:128 sc1
    s_waitcnt vmcnt(0)
    v_cmp_le_u32 vcc, 16, v21
    s_mov_b64 exec, -1
    s_nop 3
    s_or_b32 s62, vcc_lo, 0xffff0000
    s_not_b32 s62, s62
    s_ff1_i32_b32 s62, s62
    s_cmp_eq_u32 s62, -1
    s_cselect_b32 s62, 16, s62
    s_cmp_lt_u32 s12, s62
    s_cbranch_scc1 Lld_28
    s_sleep 8
    s_sub_u32 s63, s63, 1
    s_cbranch_scc0 Llp_27
    s_branch Ldf_25
Lld_28:
    v_mov_b32 v20, 159792
    v_mov_b32 v21, s62
    ds_write_b32 v20, v21
    buffer_inv sc1
    s_waitcnt vmcnt(0) lgkmcnt(0)
    v_mov_b32 v21, 0
    s_branch Ldr_26
Ldf_25:
    v_mov_b32 v21, 1
Ldr_26:
    v_mov_b32 v20, 159760
    ds_write_b32 v20, v21
    s_waitcnt lgkmcnt(0)
Ldw_24:
    s_barrier
    v_mov_b32 v20, 159760
    ds_read_b32 v21, v20
    s_waitcnt lgkmcnt(0)
    v_readfirstlane_b32 s62, v21
    s_nop 3
    s_cmp_lg_u32 s62, 0
    s_cbranch_scc1 Lendf_3
    v_mov_b32 v20, 159792
    ds_read_b32 v21, v20
    s_waitcnt lgkmcnt(0)
    v_readfirstlane_b32 s59, v21
    s_nop 3
Llr_23:
    s_lshl_b32 s66, s12, 2
    s_add_u32 s65, s66, 192
    s_mov_b32 s58, 0x10000
    s_cmp_lt_u32 s13, 64
    s_cselect_b32 s58, 1, s58
    s_cmp_lg_u32 s13, 64
    s_cbranch_scc1 Lnz_29
    v_mov_b32 v24, 0
    v_mov_b32 v25, 0
    v_mov_b32 v26, 0
    v_mov_b32 v27, 0
    s_mul_i32 s14, s12, 327680
    s_mul_i32 s15, s10, 81920
    s_add_u32 s14, s14, s15
    s_add_u32 s16, s4, 0x7800000
    s_addc_u32 s17, s5, 0
    s_add_u32 s16, s16, s14
    s_addc_u32 s17, s17, 0
    v_lshlrev_b32 v20, 4, v2
    s_mov_b32 s14, 0
Lzl_30:
    global_store_dwordx4 v20, v[24:27], s[16:17] offset:0 sc1
    global_store_dwordx4 v20, v[24:27], s[16:17] offset:1024 sc1
    global_store_dwordx4 v20, v[24:27], s[16:17] offset:2048 sc1
    global_store_dwordx4 v20, v[24:27], s[16:17] offset:3072 sc1
    s_add_u32 s16, s16, 4096
    s_addc_u32 s17, s17, 0
    s_add_u32 s14, s14, 1
    s_cmp_lt_u32 s14, 20
    s_cbranch_scc1 Lzl_30
Lnz_29:
    s_load_dwordx2 s[40:41], s[0:1], 16
    s_load_dwordx2 s[42:43], s[0:1], 24
    s_load_dwordx2 s[44:45], s[0:1], 32
    s_lshr_b32 s14, s13, 5
    s_add_u32 s14, s14, 1
    s_cmp_eq_u32 s14, 3
    s_cselect_b32 s14, 0, s14
    s_and_b32 s15, s13, 31
    s_waitcnt lgkmcnt(0)
    s_cmp_eq_u32 s14, 1
    s_cselect_b32 s40, s42, s40
    s_cselect_b32 s41, s43, s41
    s_cmp_eq_u32 s14, 2
    s_cselect_b32 s40, s44, s40
    s_cselect_b32 s41, s45, s41
    s_lshl_b32 s16, s15, 8
    s_add_u32 s46, s40, s16
    s_addc_u32 s47, s41, 0
    s_add_u32 s48, s46, 128
    s_addc_u32 s49, s47, 0
    s_mul_i32 s16, s12, 163840
    s_add_u32 s50, s4, 0x0
    s_addc_u32 s51, s5, 0
    s_add_u32 s50, s50, s16
    s_addc_u32 s51, s51, 0
    s_cmp_lg_u32 s14, 2
    s_cselect_b32 s17, 1, 0
    v_lshrrev_b32 v12, 3, v2
    v_and_b32 v13, 7, v2
    v_xor_b32 v14, v13, v12
    v_lshlrev_b32 v14, 4, v14
    s_lshl_b32 s20, s10, 5
    v_add_u32 v15, s20, v12
    s_mov_b32 s21, 1280
    v_mul_lo_u32 v15, v15, s21
    v_add_u32 v4, v15, v14
    v_add_u32 v5, 10240, v4
    v_add_u32 v6, 20480, v4
    v_add_u32 v7, 30720, v4
    v_bfe_u32 v14, v12, 1, 1
    v_lshlrev_b32 v14, 2, v14
    v_xor_b32 v14, v13, v14
    v_lshlrev_b32 v14, 4, v14
    s_and_b32 s20, s10, 1
    s_lshl_b32 s20, s20, 5
    v_add_u32 v15, s20, v12
    s_mov_b32 s21, 8192
    v_mul_lo_u32 v15, v15, s21
    v_add_u32 v8, v15, v14
    v_add_u32 v9, 65536, v8
    v_add_u32 v10, 131072, v8
    v_add_u32 v11, 196608, v8
    s_cmp_ge_u32 s10, 2
    s_cselect_b32 s22, s48, s46
    s_cselect_b32 s23, s49, s47
    s_mov_b32 s24, s50
    s_mov_b32 s25, s51
    s_lshl_b32 s26, s10, 12
    s_lshr_b32 s27, s10, 1
    s_and_b32 s28, s10, 1
    v_and_b32 v12, 31, v2
    s_lshl_b32 s20, s27, 6
    v_add_u32 v12, s20, v12
    v_lshlrev_b32 v12, 7, v12
    v_lshrrev_b32 v13, 5, v2
    v_and_b32 v14, 7, v2
    v_xor_b32 v13, v13, v14
    v_lshlrev_b32 v13, 4, v13
    v_add_u32 v16, v12, v13
    v_xor_b32 v17, 32, v16
    v_xor_b32 v18, 64, v16
    v_xor_b32 v19, 96, v16
    v_bfe_u32 v12, v2, 4, 1
    v_lshrrev_b32 v13, 5, v2
    v_bfe_u32 v14, v2, 2, 2
    v_and_b32 v15, 3, v2
    v_lshlrev_b32 v20, 3, v13
    v_add_u32 v20, v20, v14
    v_lshlrev_b32 v20, 7, v20
    v_lshlrev_b32 v21, 1, v12
    v_lshrrev_b32 v22, 1, v15
    v_add_u32 v21, v21, v22
    v_lshrrev_b32 v22, 1, v14
    v_lshlrev_b32 v22, 2, v22
    v_xor_b32 v21, v21, v22
    v_lshlrev_b32 v21, 4, v21
    v_and_b32 v22, 1, v15
    v_lshlrev_b32 v22, 3, v22
    v_add3_u32 v20, v20, v21, v22
    s_lshl_b32 s20, s28, 13
    s_add_u32 s20, s20, 16384
    v_add_u32 v20, s20, v20
    v_xor_b32 v21, 64, v20
    v_mov_b32 v64, 0
    v_mov_b32 v65, 0
    v_mov_b32 v66, 0
    v_mov_b32 v67, 0
    v_mov_b32 v68, 0
    v_mov_b32 v69, 0
    v_mov_b32 v70, 0
    v_mov_b32 v71, 0
    v_mov_b32 v72, 0
    v_mov_b32 v73, 0
    v_mov_b32 v74, 0
    v_mov_b32 v75, 0
    v_mov_b32 v76, 0
    v_mov_b32 v77, 0
    v_mov_b32 v78, 0
    v_mov_b32 v79, 0
    v_mov_b32 v80, 0
    v_mov_b32 v81, 0
    v_mov_b32 v82, 0
    v_mov_b32 v83, 0
    v_mov_b32 v84, 0
    v_mov_b32 v85, 0
    v_mov_b32 v86, 0
    v_mov_b32 v87, 0
    v_mov_b32 v88, 0
    v_mov_b32 v89, 0
    v_mov_b32 v90, 0
    v_mov_b32 v91, 0
    v_mov_b32 v92, 0
    v_mov_b32 v93, 0
    v_mov_b32 v94, 0
    v_mov_b32 v95, 0
    v_mov_b32 v96, 0
    v_mov_b32 v97, 0
    v_mov_b32 v98, 0
    v_mov_b32 v99, 0
    v_mov_b32 v100, 0
    v_mov_b32 v101, 0
    v_mov_b32 v102, 0
    v_mov_b32 v103, 0
    v_mov_b32 v104, 0
    v_mov_b32 v105, 0
    v_mov_b32 v106, 0
    v_mov_b32 v107, 0
    v_mov_b32 v108, 0
    v_mov_b32 v109, 0
    v_mov_b32 v110, 0
    v_mov_b32 v111, 0
    v_mov_b32 v112, 0
    v_mov_b32 v113, 0
    v_mov_b32 v114, 0
    v_mov_b32 v115, 0
    v_mov_b32 v116, 0
    v_mov_b32 v117, 0
    v_mov_b32 v118, 0
    v_mov_b32 v119, 0
    v_mov_b32 v120, 0
    v_mov_b32 v121, 0
    v_mov_b32 v122, 0
    v_mov_b32 v123, 0
    v_mov_b32 v124, 0
    v_mov_b32 v125, 0
    v_mov_b32 v126, 0
    v_mov_b32 v127, 0
    s_add_u32 m0, s26, 0
    s_nop 0
    global_load_lds_dwordx4 v4, s[24:25]
    s_add_u32 m0, s26, 1024
    s_nop 0
    global_load_lds_dwordx4 v5, s[24:25]
    s_add_u32 m0, s26, 2048
    s_nop 0
    global_load_lds_dwordx4 v6, s[24:25]
    s_add_u32 m0, s26, 3072
    s_nop 0
    global_load_lds_dwordx4 v7, s[24:25]
    s_add_u32 m0, s26, 16384
    s_nop 0
    global_load_lds_dwordx4 v8, s[22:23]
    s_add_u32 m0, s26, 17408
    s_nop 0
    global_load_lds_dwordx4 v9, s[22:23]
    s_add_u32 m0, s26, 18432
    s_nop 0
    global_load_lds_dwordx4 v10, s[22:23]
    s_add_u32 m0, s26, 19456
    s_nop 0
    global_load_lds_dwordx4 v11, s[22:23]
    s_add_u32 s24, s24, 128
    s_addc_u32 s25, s25, 0
    s_add_u32 s22, s22, 524288
    s_addc_u32 s23, s23, 0
    s_add_u32 m0, s26, 32768
    s_nop 0
    global_load_lds_dwordx4 v4, s[24:25]
    s_add_u32 m0, s26, 33792
    s_nop 0
    global_load_lds_dwordx4 v5, s[24:25]
    s_add_u32 m0, s26, 34816
    s_nop 0
    global_load_lds_dwordx4 v6, s[24:25]
    s_add_u32 m0, s26, 35840
    s_nop 0
    global_load_lds_dwordx4 v7, s[24:25]
    s_add_u32 m0, s26, 49152
    s_nop 0
    global_load_lds_dwordx4 v8, s[22:23]
    s_add_u32 m0, s26, 50176
    s_nop 0
    global_load_lds_dwordx4 v9, s[22:23]
    s_add_u32 m0, s26, 51200
    s_nop 0
    global_load_lds_dwordx4 v10, s[22:23]
    s_add_u32 m0, s26, 52224
    s_nop 0
    global_load_lds_dwordx4 v11, s[22:23]
    s_add_u32 s24, s24, 128
    s_addc_u32 s25, s25, 0
    s_add_u32 s22, s22, 524288
    s_addc_u32 s23, s23, 0
    s_add_u32 m0, s26, 65536
    s_nop 0
    global_load_lds_dwordx4 v4, s[24:25]
    s_add_u32 m0, s26, 66560
    s_nop 0
    global_load_lds_dwordx4 v5, s[24:25]
    s_add_u32 m0, s26, 67584
    s_nop 0
    global_load_lds_dwordx4 v6, s[24:25]
    s_add_u32 m0, s26, 68608
    s_nop 0
    global_load_lds_dwordx4 v7, s[24:25]
    s_add_u32 m0, s26, 81920
    s_nop 0
    global_load_lds_dwordx4 v8, s[22:23]
    s_add_u32 m0, s26, 82944
    s_nop 0
    global_load_lds_dwordx4 v9, s[22:23]
    s_add_u32 m0, s26, 83968
    s_nop 0
    global_load_lds_dwordx4 v10, s[22:23]
    s_add_u32 m0, s26, 84992
    s_nop 0
    global_load_lds_dwordx4 v11, s[22:23]
    s_add_u32 s24, s24, 128
    s_addc_u32 s25, s25, 0
    s_add_u32 s22, s22, 524288
    s_addc_u32 s23, s23, 0
    s_cmp_lg_u32 s17, 0
    s_cbranch_scc1 Lsw_31
    s_mov_b32 s29, 0
    s_mov_b32 s30, 0
    s_mov_b32 s31, 98304
Lk_33:
    s_cmp_ge_u32 s29, 8
    s_cbranch_scc1 Lt_34
    s_waitcnt vmcnt(16)
    s_branch Lg_35
Lt_34:
    s_waitcnt vmcnt(0)
Lg_35:
    s_barrier
    s_cmp_ge_u32 s29, 7
    s_cbranch_scc1 Ln_36
    s_add_u32 s32, s26, s31
    s_add_u32 m0, s32, 0
    s_nop 0
    global_load_lds_dwordx4 v4, s[24:25]
    s_add_u32 m0, s32, 1024
    s_nop 0
    global_load_lds_dwordx4 v5, s[24:25]
    s_add_u32 m0, s32, 2048
    s_nop 0
    global_load_lds_dwordx4 v6, s[24:25]
    s_add_u32 m0, s32, 3072
    s_nop 0
    global_load_lds_dwordx4 v7, s[24:25]
    s_add_u32 m0, s32, 16384
    s_nop 0
    global_load_lds_dwordx4 v8, s[22:23]
    s_add_u32 m0, s32, 17408
    s_nop 0
    global_load_lds_dwordx4 v9, s[22:23]
    s_add_u32 m0, s32, 18432
    s_nop 0
    global_load_lds_dwordx4 v10, s[22:23]
    s_add_u32 m0, s32, 19456
    s_nop 0
    global_load_lds_dwordx4 v11, s[22:23]
    s_add_u32 s24, s24, 128
    s_addc_u32 s25, s25, 0
    s_add_u32 s22, s22, 524288
    s_addc_u32 s23, s23, 0
    s_add_u32 s31, s31, 32768
    s_cmp_eq_u32 s31, 131072
    s_cselect_b32 s31, 0, s31
Ln_36:
    v_add_u32 v56, s30, v16
    v_add_u32 v57, s30, v17
    v_add_u32 v58, s30, v18
    v_add_u32 v59, s30, v19
    v_add_u32 v60, s30, v20
    v_add_u32 v61, s30, v21
    ds_read_b128 v[24:27], v56
    ds_read_b128 v[28:31], v56 offset:4096
    ds_read_b64_tr_b16 v[32:33], v60 offset:0
    ds_read_b64_tr_b16 v[34:35], v60 offset:512
    ds_read_b64_tr_b16 v[36:37], v61 offset:0
    ds_read_b64_tr_b16 v[38:39], v61 offset:512
    ds_read_b128 v[40:43], v57
    ds_read_b128 v[44:47], v57 offset:4096
    ds_read_b64_tr_b16 v[48:49], v60 offset:2048
    ds_read_b64_tr_b16 v[50:51], v60 offset:2560
    ds_read_b64_tr_b16 v[52:53], v61 offset:2048
    ds_read_b64_tr_b16 v[54:55], v61 offset:2560
    s_waitcnt lgkmcnt(6)
    v_mfma_f32_32x32x16_bf16 v[64:79], v[24:27], v[32:35], v[64:79]
    v_mfma_f32_32x32x16_bf16 v[80:95], v[24:27], v[36:39], v[80:95]
    v_mfma_f32_32x32x16_bf16 v[96:111], v[28:31], v[32:35], v[96:111]
    v_mfma_f32_32x32x16_bf16 v[112:127], v[28:31], v[36:39], v[112:127]
    ds_read_b128 v[24:27], v58
    ds_read_b128 v[28:31], v58 offset:4096
    ds_read_b64_tr_b16 v[32:33], v60 offset:4096
    ds_read_b64_tr_b16 v[34:35], v60 offset:4608
    ds_read_b64_tr_b16 v[36:37], v61 offset:4096
    ds_read_b64_tr_b16 v[38:39], v61 offset:4608
    s_waitcnt lgkmcnt(6)
    v_mfma_f32_32x32x16_bf16 v[64:79], v[40:43], v[48:51], v[64:79]
    v_mfma_f32_32x32x16_bf16 v[80:95], v[40:43], v[52:55], v[80:95]
    v_mfma_f32_32x32x16_bf16 v[96:111], v[44:47], v[48:51], v[96:111]
    v_mfma_f32_32x32x16_bf16 v[112:127], v[44:47], v[52:55], v[112:127]
    ds_read_b128 v[40:43], v59
    ds_read_b128 v[44:47], v59 offset:4096
    ds_read_b64_tr_b16 v[48:49], v60 offset:6144
    ds_read_b64_tr_b16 v[50:51], v60 offset:6656
    ds_read_b64_tr_b16 v[52:53], v61 offset:6144
    ds_read_b64_tr_b16 v[54:55], v61 offset:6656
    s_waitcnt lgkmcnt(6)
    v_mfma_f32_32x32x16_bf16 v[64:79], v[24:27], v[32:35], v[64:79]
    v_mfma_f32_32x32x16_bf16 v[80:95], v[24:27], v[36:39], v[80:95]
    v_mfma_f32_32x32x16_bf16 v[96:111], v[28:31], v[32:35], v[96:111]
    v_mfma_f32_32x32x16_bf16 v[112:127], v[28:31], v[36:39], v[112:127]
    s_waitcnt lgkmcnt(0)
    v_mfma_f32_32x32x16_bf16 v[64:79], v[40:43], v[48:51], v[64:79]
    v_mfma_f32_32x32x16_bf16 v[80:95], v[40:43], v[52:55], v[80:95]
    v_mfma_f32_32x32x16_bf16 v[96:111], v[44:47], v[48:51], v[96:111]
    v_mfma_f32_32x32x16_bf16 v[112:127], v[44:47], v[52:55], v[112:127]
    s_add_u32 s30, s30, 32768
    s_cmp_eq_u32 s30, 131072
    s_cselect_b32 s30, 0, s30
    s_add_u32 s29, s29, 1
    s_cmp_lt_u32 s29, 10
    s_cbranch_scc1 Lk_33
    s_branch Lsd_32
Lsw_31:
    s_mov_b32 s29, 0
    s_mov_b32 s30, 0
    s_mov_b32 s31, 98304
Lk_37:
    s_cmp_ge_u32 s29, 8
    s_cbranch_scc1 Lt_38
    s_waitcnt vmcnt(16)
    s_branch Lg_39
Lt_38:
    s_waitcnt vmcnt(0)
Lg_39:
    s_barrier
    s_cmp_ge_u32 s29, 7
    s_cbranch_scc1 Ln_40
    s_add_u32 s32, s26, s31
    s_add_u32 m0, s32, 0
    s_nop 0
    global_load_lds_dwordx4 v4, s[24:25]
    s_add_u32 m0, s32, 1024
    s_nop 0
    global_load_lds_dwordx4 v5, s[24:25]
    s_add_u32 m0, s32, 2048
    s_nop 0
    global_load_lds_dwordx4 v6, s[24:25]
    s_add_u32 m0, s32, 3072
    s_nop 0
    global_load_lds_dwordx4 v7, s[24:25]
    s_add_u32 m0, s32, 16384
    s_nop 0
    global_load_lds_dwordx4 v8, s[22:23]
    s_add_u32 m0, s32, 17408
    s_nop 0
    global_load_lds_dwordx4 v9, s[22:23]
    s_add_u32 m0, s32, 18432
    s_nop 0
    global_load_lds_dwordx4 v10, s[22:23]
    s_add_u32 m0, s32, 19456
    s_nop 0
    global_load_lds_dwordx4 v11, s[22:23]
    s_add_u32 s24, s24, 128
    s_addc_u32 s25, s25, 0
    s_add_u32 s22, s22, 524288
    s_addc_u32 s23, s23, 0
    s_add_u32 s31, s31, 32768
    s_cmp_eq_u32 s31, 131072
    s_cselect_b32 s31, 0, s31
Ln_40:
    v_add_u32 v56, s30, v16
    v_add_u32 v57, s30, v17
    v_add_u32 v58, s30, v18
    v_add_u32 v59, s30, v19
    v_add_u32 v60, s30, v20
    v_add_u32 v61, s30, v21
    ds_read_b128 v[24:27], v56
    ds_read_b128 v[28:31], v56 offset:4096
    ds_read_b64_tr_b16 v[32:33], v60 offset:0
    ds_read_b64_tr_b16 v[34:35], v60 offset:512
    ds_read_b64_tr_b16 v[36:37], v61 offset:0
    ds_read_b64_tr_b16 v[38:39], v61 offset:512
    ds_read_b128 v[40:43], v57
    ds_read_b128 v[44:47], v57 offset:4096
    ds_read_b64_tr_b16 v[48:49], v60 offset:2048
    ds_read_b64_tr_b16 v[50:51], v60 offset:2560
    ds_read_b64_tr_b16 v[52:53], v61 offset:2048
    ds_read_b64_tr_b16 v[54:55], v61 offset:2560
    s_waitcnt lgkmcnt(6)
    v_mfma_f32_32x32x16_bf16 v[64:79], v[32:35], v[24:27], v[64:79]
    v_mfma_f32_32x32x16_bf16 v[80:95], v[36:39], v[24:27], v[80:95]
    v_mfma_f32_32x32x16_bf16 v[96:111], v[32:35], v[28:31], v[96:111]
    v_mfma_f32_32x32x16_bf16 v[112:127], v[36:39], v[28:31], v[112:127]
    ds_read_b128 v[24:27], v58
    ds_read_b128 v[28:31], v58 offset:4096
    ds_read_b64_tr_b16 v[32:33], v60 offset:4096
    ds_read_b64_tr_b16 v[34:35], v60 offset:4608
    ds_read_b64_tr_b16 v[36:37], v61 offset:4096
    ds_read_b64_tr_b16 v[38:39], v61 offset:4608
    s_waitcnt lgkmcnt(6)
    v_mfma_f32_32x32x16_bf16 v[64:79], v[48:51], v[40:43], v[64:79]
    v_mfma_f32_32x32x16_bf16 v[80:95], v[52:55], v[40:43], v[80:95]
    v_mfma_f32_32x32x16_bf16 v[96:111], v[48:51], v[44:47], v[96:111]
    v_mfma_f32_32x32x16_bf16 v[112:127], v[52:55], v[44:47], v[112:127]
    ds_read_b128 v[40:43], v59
    ds_read_b128 v[44:47], v59 offset:4096
    ds_read_b64_tr_b16 v[48:49], v60 offset:6144
    ds_read_b64_tr_b16 v[50:51], v60 offset:6656
    ds_read_b64_tr_b16 v[52:53], v61 offset:6144
    ds_read_b64_tr_b16 v[54:55], v61 offset:6656
    s_waitcnt lgkmcnt(6)
    v_mfma_f32_32x32x16_bf16 v[64:79], v[32:35], v[24:27], v[64:79]
    v_mfma_f32_32x32x16_bf16 v[80:95], v[36:39], v[24:27], v[80:95]
    v_mfma_f32_32x32x16_bf16 v[96:111], v[32:35], v[28:31], v[96:111]
    v_mfma_f32_32x32x16_bf16 v[112:127], v[36:39], v[28:31], v[112:127]
    s_waitcnt lgkmcnt(0)
    v_mfma_f32_32x32x16_bf16 v[64:79], v[48:51], v[40:43], v[64:79]
    v_mfma_f32_32x32x16_bf16 v[80:95], v[52:55], v[40:43], v[80:95]
    v_mfma_f32_32x32x16_bf16 v[96:111], v[48:51], v[44:47], v[96:111]
    v_mfma_f32_32x32x16_bf16 v[112:127], v[52:55], v[44:47], v[112:127]
    s_add_u32 s30, s30, 32768
    s_cmp_eq_u32 s30, 131072
    s_cselect_b32 s30, 0, s30
    s_add_u32 s29, s29, 1
    s_cmp_lt_u32 s29, 10
    s_cbranch_scc1 Lk_37
Lsd_32:
    s_nop 15
    s_barrier
    s_lshl_b32 s16, s14, 24
    s_add_u32 s16, s16, 0x400000
    s_add_u32 s52, s4, s16
    s_addc_u32 s53, s5, 0
    s_lshl_b32 s18, s12, 2
    s_lshl_b32 s19, s27, 1
    s_add_u32 s18, s18, s19
    s_lshl_b32 s18, s18, 5
    s_add_u32 s18, s18, s15
    s_lshl_b32 s18, s18, 13
    s_add_u32 s52, s52, s18
    s_addc_u32 s53, s53, 0
    s_cmp_eq_u32 s17, 0
    s_cbranch_scc1 Lv_41
    v_bfe_u32 v4, v2, 4, 1
    v_lshlrev_b32 v4, 12, v4
    v_and_b32 v5, 15, v2
    v_lshlrev_b32 v5, 4, v5
    v_lshrrev_b32 v6, 5, v2
    v_lshlrev_b32 v6, 8, v6
    v_add3_u32 v4, v4, v5, v6
    s_lshl_b32 s19, s28, 11
    v_add_u32 v4, s19, v4
    v_cvt_pk_bf16_f32 v8, v64, v65
    v_cvt_pk_bf16_f32 v9, v66, v67
    v_cvt_pk_bf16_f32 v10, v68, v69
    v_cvt_pk_bf16_f32 v11, v70, v71
    s_nop 1
    v_permlane32_swap_b32 v8, v10
    v_permlane32_swap_b32 v9, v11
    global_store_dwordx4 v4, v[8:11], s[52:53] offset:0 sc1
    s_nop 1
    v_cvt_pk_bf16_f32 v8, v72, v73
    v_cvt_pk_bf16_f32 v9, v74, v75
    v_cvt_pk_bf16_f32 v10, v76, v77
    v_cvt_pk_bf16_f32 v11, v78, v79
    s_nop 1
    v_permlane32_swap_b32 v8, v10
    v_permlane32_swap_b32 v9, v11
    global_store_dwordx4 v4, v[8:11], s[52:53] offset:512 sc1
    s_nop 1
    v_cvt_pk_bf16_f32 v8, v80, v81
    v_cvt_pk_bf16_f32 v9, v82, v83
    v_cvt_pk_bf16_f32 v10, v84, v85
    v_cvt_pk_bf16_f32 v11, v86, v87
    s_nop 1
    v_permlane32_swap_b32 v8, v10
    v_permlane32_swap_b32 v9, v11
    global_store_dwordx4 v4, v[8:11], s[52:53] offset:1024 sc1
    s_nop 1
    v_cvt_pk_bf16_f32 v8, v88, v89
    v_cvt_pk_bf16_f32 v9, v90, v91
    v_cvt_pk_bf16_f32 v10, v92, v93
    v_cvt_pk_bf16_f32 v11, v94, v95
    s_nop 1
    v_permlane32_swap_b32 v8, v10
    v_permlane32_swap_b32 v9, v11
    global_store_dwordx4 v4, v[8:11], s[52:53] offset:1536 sc1
    s_nop 1
    v_add_u32 v4, 262144, v4
    v_cvt_pk_bf16_f32 v8, v96, v97
    v_cvt_pk_bf16_f32 v9, v98, v99
    v_cvt_pk_bf16_f32 v10, v100, v101
    v_cvt_pk_bf16_f32 v11, v102, v103
    s_nop 1
    v_permlane32_swap_b32 v8, v10
    v_permlane32_swap_b32 v9, v11
    global_store_dwordx4 v4, v[8:11], s[52:53] offset:0 sc1
    s_nop 1
    v_cvt_pk_bf16_f32 v8, v104, v105
    v_cvt_pk_bf16_f32 v9, v106, v107
    v_cvt_pk_bf16_f32 v10, v108, v109
    v_cvt_pk_bf16_f32 v11, v110, v111
    s_nop 1
    v_permlane32_swap_b32 v8, v10
    v_permlane32_swap_b32 v9, v11
    global_store_dwordx4 v4, v[8:11], s[52:53] offset:512 sc1
    s_nop 1
    v_cvt_pk_bf16_f32 v8, v112, v113
    v_cvt_pk_bf16_f32 v9, v114, v115
    v_cvt_pk_bf16_f32 v10, v116, v117
    v_cvt_pk_bf16_f32 v11, v118, v119
    s_nop 1
    v_permlane32_swap_b32 v8, v10
    v_permlane32_swap_b32 v9, v11
    global_store_dwordx4 v4, v[8:11], s[52:53] offset:1024 sc1
    s_nop 1
    v_cvt_pk_bf16_f32 v8, v120, v121
    v_cvt_pk_bf16_f32 v9, v122, v123
    v_cvt_pk_bf16_f32 v10, v124, v125
    v_cvt_pk_bf16_f32 v11, v126, v127
    s_nop 1
    v_permlane32_swap_b32 v8, v10
    v_permlane32_swap_b32 v9, v11
    global_store_dwordx4 v4, v[8:11], s[52:53] offset:1536 sc1
    s_nop 1
    s_branch Ld_42
Lv_41:
    v_bfe_u32 v4, v2, 4, 1
    v_lshlrev_b32 v4, 10, v4
    v_and_b32 v5, 15, v2
    v_lshlrev_b32 v5, 4, v5
    v_lshrrev_b32 v6, 5, v2
    v_lshlrev_b32 v6, 8, v6
    v_add3_u32 v4, v4, v5, v6
    s_lshl_b32 s19, s28, 12
    v_add_u32 v4, s19, v4
    v_cvt_pk_bf16_f32 v8, v64, v65
    v_cvt_pk_bf16_f32 v9, v66, v67
    v_cvt_pk_bf16_f32 v10, v72, v73
    v_cvt_pk_bf16_f32 v11, v74, v75
    global_store_dwordx4 v4, v[8:11], s[52:53] offset:0 sc1
    s_nop 1
    v_cvt_pk_bf16_f32 v8, v68, v69
    v_cvt_pk_bf16_f32 v9, v70, v71
    v_cvt_pk_bf16_f32 v10, v76, v77
    v_cvt_pk_bf16_f32 v11, v78, v79
    global_store_dwordx4 v4, v[8:11], s[52:53] offset:512 sc1
    s_nop 1
    v_cvt_pk_bf16_f32 v8, v80, v81
    v_cvt_pk_bf16_f32 v9, v82, v83
    v_cvt_pk_bf16_f32 v10, v88, v89
    v_cvt_pk_bf16_f32 v11, v90, v91
    global_store_dwordx4 v4, v[8:11], s[52:53] offset:2048 sc1
    s_nop 1
    v_cvt_pk_bf16_f32 v8, v84, v85
    v_cvt_pk_bf16_f32 v9, v86, v87
    v_cvt_pk_bf16_f32 v10, v92, v93
    v_cvt_pk_bf16_f32 v11, v94, v95
    global_store_dwordx4 v4, v[8:11], s[52:53] offset:2560 sc1
    s_nop 1
    v_add_u32 v4, 262144, v4
    v_cvt_pk_bf16_f32 v8, v96, v97
    v_cvt_pk_bf16_f32 v9, v98, v99
    v_cvt_pk_bf16_f32 v10, v104, v105
    v_cvt_pk_bf16_f32 v11, v106, v107
    global_store_dwordx4 v4, v[8:11], s[52:53] offset:0 sc1
    s_nop 1
    v_cvt_pk_bf16_f32 v8, v100, v101
    v_cvt_pk_bf16_f32 v9, v102, v103
    v_cvt_pk_bf16_f32 v10, v108, v109
    v_cvt_pk_bf16_f32 v11, v110, v111
    global_store_dwordx4 v4, v[8:11], s[52:53] offset:512 sc1
    s_nop 1
    v_cvt_pk_bf16_f32 v8, v112, v113
    v_cvt_pk_bf16_f32 v9, v114, v115
    v_cvt_pk_bf16_f32 v10, v120, v121
    v_cvt_pk_bf16_f32 v11, v122, v123
    global_store_dwordx4 v4, v[8:11], s[52:53] offset:2048 sc1
    s_nop 1
    v_cvt_pk_bf16_f32 v8, v116, v117
    v_cvt_pk_bf16_f32 v9, v118, v119
    v_cvt_pk_bf16_f32 v10, v124, v125
    v_cvt_pk_bf16_f32 v11, v126, v127
    global_store_dwordx4 v4, v[8:11], s[52:53] offset:2560 sc1
    s_nop 1
Ld_42:
    s_waitcnt vmcnt(0)
    s_barrier
    s_cmp_lg_u32 s10, 0
    s_cbranch_scc1 Lsg_43
    s_mov_b64 exec, 1
    v_mov_b32 v20, s65
    v_mov_b32 v21, s58
    global_atomic_add v20, v21, s[6:7]
    s_mov_b64 exec, -1
Lsg_43:
    s_branch Lw_10
Lroles_11:
    s_cmp_lg_u32 s10, 0
    s_cbranch_scc1 Lnf_44
    s_mov_b64 exec, 1
    v_mov_b32 v20, 0x28
    v_mov_b32 v21, 1
    global_atomic_add v22, v20, v21, s[6:7] sc0
    s_waitcnt vmcnt(0)
    v_mov_b32 v20, 159744
    ds_write_b32 v20, v22
    s_waitcnt lgkmcnt(0)
    s_mov_b64 exec, -1
Lnf_44:
    s_barrier
    v_mov_b32 v20, 159744
    ds_read_b32 v22, v20
    s_waitcnt lgkmcnt(0)
    v_readfirstlane_b32 s61, v22
    s_nop 3
    s_barrier
    s_cmp_lt_u32 s61, 32
    s_cbranch_scc1 Lrat_45
    s_sub_u32 s64, s61, 32
    s_cmp_lt_u32 s64, 80
    s_cbranch_scc1 Lrwo_46
    s_sub_u32 s64, s64, 80
    s_cmp_lt_u32 s64, 12
    s_cbranch_scc1 Lrln_49
    s_sub_u32 s64, s64, 12
    s_cmp_lt_u32 s64, 54
    s_cbranch_scc1 Lrgu_47
    s_sub_u32 s64, s64, 54
    s_cmp_lt_u32 s64, 45
    s_cbranch_scc1 Lrdn_48
    s_branch Lendf_3
Lrat_45:
    s_and_b32 s70, s61, 7
    s_lshr_b32 s71, s61, 3
    s_lshl_b32 s13, s70, 2
    s_add_u32 s13, s13, s10
    s_mov_b32 s12, s71
    v_lshlrev_b32 v3, 4, v2
    v_add_u32 v4, 4096, v3
    v_lshlrev_b32 v5, 3, v2
    s_mov_b32 s16, 0x3e0293ee
Lat_50:
    s_lshr_b32 s30, s12, 2
    s_lshl_b32 s30, s30, 2
    s_add_u32 s31, s30, 192
    s_mov_b32 s32, 0x200040
    s_cmp_lg_u32 s10, 0
    s_cbranch_scc1 Ldw_51
    v_mov_b32 v20, s31
Lq_54:
    global_load_dword v21, v20, s[6:7] sc1
    s_waitcnt vmcnt(0)
    v_readfirstlane_b32 s62, v21
    s_nop 3
    s_cmp_ge_u32 s62, s32
    s_cbranch_scc1 Lqo_55
    s_sleep 2
    s_sub_u32 s63, s63, 1
    s_cbranch_scc0 Lq_54
    s_branch Ldf_52
Lqo_55:
    v_mov_b32 v21, 0
    s_branch Ldr_53
Ldf_52:
    v_mov_b32 v21, 1
Ldr_53:
    v_mov_b32 v20, 159760
    ds_write_b32 v20, v21
    s_waitcnt lgkmcnt(0)
Ldw_51:
    s_barrier
    v_mov_b32 v20, 159760
    ds_read_b32 v21, v20
    s_waitcnt lgkmcnt(0)
    v_readfirstlane_b32 s62, v21
    s_nop 3
    s_cmp_lg_u32 s62, 0
    s_cbranch_scc1 Lendf_3
    s_lshl_b32 s14, s12, 5
    s_add_u32 s14, s14, s13
    s_lshl_b32 s15, s14, 13
    s_add_u32 s20, s4, 0x400000
    s_addc_u32 s21, s5, 0
    s_add_u32 s20, s20, s15
    s_addc_u32 s21, s21, 0
    s_add_u32 s22, s4, 0x1400000
    s_addc_u32 s23, s5, 0
    s_add_u32 s22, s22, s15
    s_addc_u32 s23, s23, 0
    s_add_u32 s24, s4, 0x2400000
    s_addc_u32 s25, s5, 0
    s_add_u32 s24, s24, s15
    s_addc_u32 s25, s25, 0
    s_lshl_b32 s15, s14, 12
    s_add_u32 s26, s4, 0x3400000
    s_addc_u32 s27, s5, 0
    s_add_u32 s26, s26, s15
    s_addc_u32 s27, s27, 0
    s_lshl_b32 s15, s14, 11
    s_add_u32 s28, s4, 0x3c00000
    s_addc_u32 s29, s5, 0
    s_add_u32 s28, s28, s15
    s_addc_u32 s29, s29, 0
    global_load_dwordx4 v[32:35], v3, s[20:21] offset:0 sc1
    global_load_dwordx4 v[36:39], v3, s[20:21] offset:1024 sc1
    global_load_dwordx4 v[40:43], v3, s[20:21] offset:2048 sc1
    global_load_dwordx4 v[44:47], v3, s[20:21] offset:3072 sc1
    global_load_dwordx4 v[48:51], v4, s[20:21] offset:0 sc1
    global_load_dwordx4 v[52:55], v4, s[20:21] offset:1024 sc1
    global_load_dwordx4 v[56:59], v4, s[20:21] offset:2048 sc1
    global_load_dwordx4 v[60:63], v4, s[20:21] offset:3072 sc1
    global_load_dwordx4 v[64:67], v3, s[22:23] offset:0 sc1
    global_load_dwordx4 v[68:71], v3, s[22:23] offset:1024 sc1
    global_load_dwordx4 v[72:75], v3, s[22:23] offset:2048 sc1
    global_load_dwordx4 v[76:79], v3, s[22:23] offset:3072 sc1
    global_load_dwordx4 v[80:83], v4, s[22:23] offset:0 sc1
    global_load_dwordx4 v[84:87], v4, s[22:23] offset:1024 sc1
    global_load_dwordx4 v[88:91], v4, s[22:23] offset:2048 sc1
    global_load_dwordx4 v[92:95], v4, s[22:23] offset:3072 sc1
    global_load_dwordx4 v[192:195], v3, s[24:25] offset:0 sc1
    global_load_dwordx4 v[196:199], v3, s[24:25] offset:1024 sc1
    global_load_dwordx4 v[200:203], v3, s[24:25] offset:2048 sc1
    global_load_dwordx4 v[204:207], v3, s[24:25] offset:3072 sc1
    global_load_dwordx4 v[208:211], v4, s[24:25] offset:0 sc1
    global_load_dwordx4 v[212:215], v4, s[24:25] offset:1024 sc1
    global_load_dwordx4 v[216:219], v4, s[24:25] offset:2048 sc1
    global_load_dwordx4 v[220:223], v4, s[24:25] offset:3072 sc1
    s_waitcnt vmcnt(8)
    v_mfma_f32_16x16x32_bf16 v[120:123], v[64:67], v[32:35], 0
    v_mfma_f32_16x16x32_bf16 v[124:127], v[64:67], v[48:51], 0
    v_mfma_f32_16x16x32_bf16 v[132:135], v[80:83], v[48:51], 0
    v_mfma_f32_16x16x32_bf16 v[120:123], v[68:71], v[36:39], v[120:123]
    v_mfma_f32_16x16x32_bf16 v[124:127], v[68:71], v[52:55], v[124:127]
    v_mfma_f32_16x16x32_bf16 v[132:135], v[84:87], v[52:55], v[132:135]
    v_mfma_f32_16x16x32_bf16 v[120:123], v[72:75], v[40:43], v[120:123]
    v_mfma_f32_16x16x32_bf16 v[124:127], v[72:75], v[56:59], v[124:127]
    v_mfma_f32_16x16x32_bf16 v[132:135], v[88:91], v[56:59], v[132:135]
    v_mfma_f32_16x16x32_bf16 v[120:123], v[76:79], v[44:47], v[120:123]
    v_mfma_f32_16x16x32_bf16 v[124:127], v[76:79], v[60:63], v[124:127]
    v_mfma_f32_16x16x32_bf16 v[132:135], v[92:95], v[60:63], v[132:135]
    v_lshrrev_b32 v6, 4, v2
    v_lshlrev_b32 v6, 2, v6
    v_and_b32 v7, 15, v2
    v_mov_b32 v8, 0xff800000
    s_nop 7
    v_add_u32 v9, 0, v6
    v_cmp_gt_u32 vcc, v9, v7
    s_nop 1
    v_cndmask_b32 v120, v120, v8, vcc
    v_cndmask_b32 v132, v132, v8, vcc
    v_add_u32 v9, 1, v6
    v_cmp_gt_u32 vcc, v9, v7
    s_nop 1
    v_cndmask_b32 v121, v121, v8, vcc
    v_cndmask_b32 v133, v133, v8, vcc
    v_add_u32 v9, 2, v6
    v_cmp_gt_u32 vcc, v9, v7
    s_nop 1
    v_cndmask_b32 v122, v122, v8, vcc
    v_cndmask_b32 v134, v134, v8, vcc
    v_add_u32 v9, 3, v6
    v_cmp_gt_u32 vcc, v9, v7
    s_nop 1
    v_cndmask_b32 v123, v123, v8, vcc
    v_cndmask_b32 v135, v135, v8, vcc
    s_lshl_b32 s31, s70, 7
    s_add_u32 s31, s31, 0x7403000
    s_add_u32 s32, s12, 1
    s_cmp_lg_u32 s10, 0
    s_cbranch_scc1 Ldw_56
    v_mov_b32 v20, s31
Lq_59:
    global_load_dwordx4 v[24:27], v20, s[4:5] sc1
    s_waitcnt vmcnt(0)
    v_min_u32 v21, v24, v25
    v_min_u32 v22, v26, v27
    v_min_u32 v21, v21, v22
    s_nop 0
    v_readfirstlane_b32 s62, v21
    s_nop 3
    s_cmp_ge_u32 s62, s32
    s_cbranch_scc1 Lqo_60
    s_sleep 2
    s_sub_u32 s63, s63, 1
    s_cbranch_scc0 Lq_59
    s_branch Ldf_57
Lqo_60:
    v_mov_b32 v21, 0
    s_branch Ldr_58
Ldf_57:
    v_mov_b32 v21, 1
Ldr_58:
    v_mov_b32 v20, 159760
    ds_write_b32 v20, v21
    s_waitcnt lgkmcnt(0)
Ldw_56:
    s_barrier
    v_mov_b32 v20, 159760
    ds_read_b32 v21, v20
    s_waitcnt lgkmcnt(0)
    v_readfirstlane_b32 s62, v21
    s_nop 3
    s_cmp_lg_u32 s62, 0
    s_cbranch_scc1 Lendf_3
    global_load_dwordx4 v[96:99], v3, s[26:27] offset:0 sc1
    global_load_dwordx4 v[100:103], v3, s[26:27] offset:1024 sc1
    global_load_dwordx4 v[104:107], v3, s[26:27] offset:2048 sc1
    global_load_dwordx4 v[108:111], v3, s[26:27] offset:3072 sc1
    global_load_dwordx2 v[224:225], v5, s[28:29] offset:0 sc1
    global_load_dwordx2 v[226:227], v5, s[28:29] offset:512 sc1
    global_load_dwordx2 v[228:229], v5, s[28:29] offset:1024 sc1
    global_load_dwordx2 v[230:231], v5, s[28:29] offset:1536 sc1
    s_waitcnt vmcnt(4)
    v_mfma_f32_16x16x32_bf16 v[112:115], v[96:99], v[32:35], 0
    v_mfma_f32_16x16x32_bf16 v[116:119], v[96:99], v[48:51], 0
    v_mfma_f32_16x16x32_bf16 v[112:115], v[100:103], v[36:39], v[112:115]
    v_mfma_f32_16x16x32_bf16 v[116:119], v[100:103], v[52:55], v[116:119]
    v_mfma_f32_16x16x32_bf16 v[112:115], v[104:107], v[40:43], v[112:115]
    v_mfma_f32_16x16x32_bf16 v[116:119], v[104:107], v[56:59], v[116:119]
    v_mfma_f32_16x16x32_bf16 v[112:115], v[108:111], v[44:47], v[112:115]
    v_mfma_f32_16x16x32_bf16 v[116:119], v[108:111], v[60:63], v[116:119]
    v_mov_b32 v12, 0x3f803f80
    v_mov_b32 v13, 0x3f803f80
    v_mov_b32 v14, 0x3f803f80
    v_mov_b32 v15, 0x3f803f80
    s_nop 4
    v_max3_f32 v10, v112, v113, v114
    v_max3_f32 v10, v10, v115, v120
    v_max3_f32 v10, v10, v121, v122
    v_max_f32 v10, v10, v123
    v_mov_b32 v11, v10
    s_nop 1
    v_permlane16_swap_b32 v10, v11
    v_max_f32 v10, v10, v11
    v_mov_b32 v11, v10
    s_nop 1
    v_permlane32_swap_b32 v10, v11
    v_max_f32 v10, v10, v11
    v_mul_f32 v10, s16, v10
    v_fma_f32 v112, v112, s16, -v10
    v_fma_f32 v113, v113, s16, -v10
    v_fma_f32 v114, v114, s16, -v10
    v_fma_f32 v115, v115, s16, -v10
    v_fma_f32 v120, v120, s16, -v10
    v_fma_f32 v121, v121, s16, -v10
    v_fma_f32 v122, v122, s16, -v10
    v_fma_f32 v123, v123, s16, -v10
    v_exp_f32 v112, v112
    v_exp_f32 v113, v113
    v_exp_f32 v114, v114
    v_exp_f32 v115, v115
    v_exp_f32 v120, v120
    v_exp_f32 v121, v121
    v_exp_f32 v122, v122
    v_exp_f32 v123, v123
    s_nop 0
    v_cvt_pk_bf16_f32 v64, v120, v121
    v_cvt_pk_bf16_f32 v65, v122, v123
    v_mov_b32 v66, 0
    v_mov_b32 v67, 0
    v_cvt_pk_bf16_f32 v10, v112, v113
    v_cvt_pk_bf16_f32 v11, v114, v115
    v_cndmask_b32_e64 v68, 0, v10, s[96:97]
    v_cndmask_b32_e64 v69, 0, v11, s[96:97]
    v_cndmask_b32_e64 v70, v10, 0, s[96:97]
    v_cndmask_b32_e64 v71, v11, 0, s[96:97]
    v_max3_f32 v10, v116, v117, v118
    v_max3_f32 v10, v10, v119, v124
    v_max3_f32 v10, v10, v125, v126
    v_max3_f32 v10, v10, v127, v132
    v_max3_f32 v10, v10, v133, v134
    v_max_f32 v10, v10, v135
    v_mov_b32 v11, v10
    s_nop 1
    v_permlane16_swap_b32 v10, v11
    v_max_f32 v10, v10, v11
    v_mov_b32 v11, v10
    s_nop 1
    v_permlane32_swap_b32 v10, v11
    v_max_f32 v10, v10, v11
    v_mul_f32 v10, s16, v10
    v_fma_f32 v116, v116, s16, -v10
    v_fma_f32 v117, v117, s16, -v10
    v_fma_f32 v118, v118, s16, -v10
    v_fma_f32 v119, v119, s16, -v10
    v_fma_f32 v124, v124, s16, -v10
    v_fma_f32 v125, v125, s16, -v10
    v_fma_f32 v126, v126, s16, -v10
    v_fma_f32 v127, v127, s16, -v10
    v_fma_f32 v132, v132, s16, -v10
    v_fma_f32 v133, v133, s16, -v10
    v_fma_f32 v134, v134, s16, -v10
    v_fma_f32 v135, v135, s16, -v10
    v_exp_f32 v116, v116
    v_exp_f32 v117, v117
    v_exp_f32 v118, v118
    v_exp_f32 v119, v119
    v_exp_f32 v124, v124
    v_exp_f32 v125, v125
    v_exp_f32 v126, v126
    v_exp_f32 v127, v127
    v_exp_f32 v132, v132
    v_exp_f32 v133, v133
    v_exp_f32 v134, v134
    v_exp_f32 v135, v135
    s_nop 0
    v_cvt_pk_bf16_f32 v72, v124, v125
    v_cvt_pk_bf16_f32 v73, v126, v127
    v_cvt_pk_bf16_f32 v74, v132, v133
    v_cvt_pk_bf16_f32 v75, v134, v135
    v_cvt_pk_bf16_f32 v10, v116, v117
    v_cvt_pk_bf16_f32 v11, v118, v119
    v_cndmask_b32_e64 v76, 0, v10, s[96:97]
    v_cndmask_b32_e64 v77, 0, v11, s[96:97]
    v_cndmask_b32_e64 v78, v10, 0, s[96:97]
    v_cndmask_b32_e64 v79, v11, 0, s[96:97]
    s_waitcnt vmcnt(0)
    v_mfma_f32_16x16x32_bf16 v[16:19], v[12:15], v[64:67], 0
    v_mfma_f32_16x16x32_bf16 v[128:131], v[192:195], v[64:67], 0
    v_mfma_f32_16x16x32_bf16 v[132:135], v[196:199], v[64:67], 0
    v_mfma_f32_16x16x32_bf16 v[136:139], v[200:203], v[64:67], 0
    v_mfma_f32_16x16x32_bf16 v[140:143], v[204:207], v[64:67], 0
    v_mfma_f32_16x16x32_bf16 v[144:147], v[208:211], v[64:67], 0
    v_mfma_f32_16x16x32_bf16 v[148:151], v[212:215], v[64:67], 0
    v_mfma_f32_16x16x32_bf16 v[152:155], v[216:219], v[64:67], 0
    v_mfma_f32_16x16x32_bf16 v[156:159], v[220:223], v[64:67], 0
    v_mfma_f32_16x16x32_bf16 v[20:23], v[12:15], v[72:75], 0
    v_mfma_f32_16x16x32_bf16 v[160:163], v[192:195], v[72:75], 0
    v_mfma_f32_16x16x32_bf16 v[164:167], v[196:199], v[72:75], 0
    v_mfma_f32_16x16x32_bf16 v[168:171], v[200:203], v[72:75], 0
    v_mfma_f32_16x16x32_bf16 v[172:175], v[204:207], v[72:75], 0
    v_mfma_f32_16x16x32_bf16 v[176:179], v[208:211], v[72:75], 0
    v_mfma_f32_16x16x32_bf16 v[180:183], v[212:215], v[72:75], 0
    v_mfma_f32_16x16x32_bf16 v[184:187], v[216:219], v[72:75], 0
    v_mfma_f32_16x16x32_bf16 v[188:191], v[220:223], v[72:75], 0
    s_nop 3
    v_mfma_f32_16x16x16_bf16 v[16:19], v[12:13], v[68:69], v[16:19]
    v_mfma_f32_16x16x16_bf16 v[128:131], v[224:225], v[68:69], v[128:131]
    v_mfma_f32_16x16x16_bf16 v[132:135], v[224:225], v[70:71], v[132:135]
    v_mfma_f32_16x16x16_bf16 v[136:139], v[226:227], v[68:69], v[136:139]
    v_mfma_f32_16x16x16_bf16 v[140:143], v[226:227], v[70:71], v[140:143]
    v_mfma_f32_16x16x16_bf16 v[144:147], v[228:229], v[68:69], v[144:147]
    v_mfma_f32_16x16x16_bf16 v[148:151], v[228:229], v[70:71], v[148:151]
    v_mfma_f32_16x16x16_bf16 v[152:155], v[230:231], v[68:69], v[152:155]
    v_mfma_f32_16x16x16_bf16 v[156:159], v[230:231], v[70:71], v[156:159]
    v_mfma_f32_16x16x16_bf16 v[20:23], v[12:13], v[76:77], v[20:23]
    v_mfma_f32_16x16x16_bf16 v[160:163], v[224:225], v[76:77], v[160:163]
    v_mfma_f32_16x16x16_bf16 v[164:167], v[224:225], v[78:79], v[164:167]
    v_mfma_f32_16x16x16_bf16 v[168:171], v[226:227], v[76:77], v[168:171]
    v_mfma_f32_16x16x16_bf16 v[172:175], v[226:227], v[78:79], v[172:175]
    v_mfma_f32_16x16x16_bf16 v[176:179], v[228:229], v[76:77], v[176:179]
    v_mfma_f32_16x16x16_bf16 v[180:183], v[228:229], v[78:79], v[180:183]
    v_mfma_f32_16x16x16_bf16 v[184:187], v[230:231], v[76:77], v[184:187]
    v_mfma_f32_16x16x16_bf16 v[188:191], v[230:231], v[78:79], v[188:191]
    s_add_u32 s30, s4, 0x4400000
    s_addc_u32 s31, s5, 0
    s_lshl_b32 s15, s12, 18
    s_lshl_b32 s17, s13, 8
    s_add_u32 s15, s15, s17
    s_add_u32 s30, s30, s15
    s_addc_u32 s31, s31, 0
    v_lshlrev_b32 v9, 13, v7
    v_bfe_u32 v10, v2, 4, 1
    v_lshlrev_b32 v10, 5, v10
    v_add_u32 v9, v9, v10
    v_lshrrev_b32 v10, 5, v2
    v_lshlrev_b32 v10, 4, v10
    v_add_u32 v9, v9, v10
    v_rcp_f32 v10, v16
    s_nop 0
    v_pk_mul_f32 v[128:129], v[128:129], v[10:11] op_sel_hi:[1,0]
    v_pk_mul_f32 v[130:131], v[130:131], v[10:11] op_sel_hi:[1,0]
    v_pk_mul_f32 v[132:133], v[132:133], v[10:11] op_sel_hi:[1,0]
    v_pk_mul_f32 v[134:135], v[134:135], v[10:11] op_sel_hi:[1,0]
    v_cvt_pk_bf16_f32 v128, v128, v129
    v_cvt_pk_bf16_f32 v129, v130, v131
    v_cvt_pk_bf16_f32 v130, v132, v133
    v_cvt_pk_bf16_f32 v131, v134, v135
    s_nop 1
    v_permlane16_swap_b32 v128, v130
    v_permlane16_swap_b32 v129, v131
    global_store_dwordx4 v9, v[128:131], s[30:31] offset:0 sc1
    v_pk_mul_f32 v[136:137], v[136:137], v[10:11] op_sel_hi:[1,0]
    v_pk_mul_f32 v[138:139], v[138:139], v[10:11] op_sel_hi:[1,0]
    v_pk_mul_f32 v[140:141], v[140:141], v[10:11] op_sel_hi:[1,0]
    v_pk_mul_f32 v[142:143], v[142:143], v[10:11] op_sel_hi:[1,0]
    v_cvt_pk_bf16_f32 v136, v136, v137
    v_cvt_pk_bf16_f32 v137, v138, v139
    v_cvt_pk_bf16_f32 v138, v140, v141
    v_cvt_pk_bf16_f32 v139, v142, v143
    s_nop 1
    v_permlane16_swap_b32 v136, v138
    v_permlane16_swap_b32 v137, v139
    global_store_dwordx4 v9, v[136:139], s[30:31] offset:64 sc1
    v_pk_mul_f32 v[144:145], v[144:145], v[10:11] op_sel_hi:[1,0]
    v_pk_mul_f32 v[146:147], v[146:147], v[10:11] op_sel_hi:[1,0]
    v_pk_mul_f32 v[148:149], v[148:149], v[10:11] op_sel_hi:[1,0]
    v_pk_mul_f32 v[150:151], v[150:151], v[10:11] op_sel_hi:[1,0]
    v_cvt_pk_bf16_f32 v144, v144, v145
    v_cvt_pk_bf16_f32 v145, v146, v147
    v_cvt_pk_bf16_f32 v146, v148, v149
    v_cvt_pk_bf16_f32 v147, v150, v151
    s_nop 1
    v_permlane16_swap_b32 v144, v146
    v_permlane16_swap_b32 v145, v147
    global_store_dwordx4 v9, v[144:147], s[30:31] offset:128 sc1
    v_pk_mul_f32 v[152:153], v[152:153], v[10:11] op_sel_hi:[1,0]
    v_pk_mul_f32 v[154:155], v[154:155], v[10:11] op_sel_hi:[1,0]
    v_pk_mul_f32 v[156:157], v[156:157], v[10:11] op_sel_hi:[1,0]
    v_pk_mul_f32 v[158:159], v[158:159], v[10:11] op_sel_hi:[1,0]
    v_cvt_pk_bf16_f32 v152, v152, v153
    v_cvt_pk_bf16_f32 v153, v154, v155
    v_cvt_pk_bf16_f32 v154, v156, v157
    v_cvt_pk_bf16_f32 v155, v158, v159
    s_nop 1
    v_permlane16_swap_b32 v152, v154
    v_permlane16_swap_b32 v153, v155
    global_store_dwordx4 v9, v[152:155], s[30:31] offset:192 sc1
    v_rcp_f32 v10, v20
    s_nop 0
    v_add_u32 v9, 131072, v9
    v_pk_mul_f32 v[160:161], v[160:161], v[10:11] op_sel_hi:[1,0]
    v_pk_mul_f32 v[162:163], v[162:163], v[10:11] op_sel_hi:[1,0]
    v_pk_mul_f32 v[164:165], v[164:165], v[10:11] op_sel_hi:[1,0]
    v_pk_mul_f32 v[166:167], v[166:167], v[10:11] op_sel_hi:[1,0]
    v_cvt_pk_bf16_f32 v160, v160, v161
    v_cvt_pk_bf16_f32 v161, v162, v163
    v_cvt_pk_bf16_f32 v162, v164, v165
    v_cvt_pk_bf16_f32 v163, v166, v167
    s_nop 1
    v_permlane16_swap_b32 v160, v162
    v_permlane16_swap_b32 v161, v163
    global_store_dwordx4 v9, v[160:163], s[30:31] offset:0 sc1
    v_pk_mul_f32 v[168:169], v[168:169], v[10:11] op_sel_hi:[1,0]
    v_pk_mul_f32 v[170:171], v[170:171], v[10:11] op_sel_hi:[1,0]
    v_pk_mul_f32 v[172:173], v[172:173], v[10:11] op_sel_hi:[1,0]
    v_pk_mul_f32 v[174:175], v[174:175], v[10:11] op_sel_hi:[1,0]
    v_cvt_pk_bf16_f32 v168, v168, v169
    v_cvt_pk_bf16_f32 v169, v170, v171
    v_cvt_pk_bf16_f32 v170, v172, v173
    v_cvt_pk_bf16_f32 v171, v174, v175
    s_nop 1
    v_permlane16_swap_b32 v168, v170
    v_permlane16_swap_b32 v169, v171
    global_store_dwordx4 v9, v[168:171], s[30:31] offset:64 sc1
    v_pk_mul_f32 v[176:177], v[176:177], v[10:11] op_sel_hi:[1,0]
    v_pk_mul_f32 v[178:179], v[178:179], v[10:11] op_sel_hi:[1,0]
    v_pk_mul_f32 v[180:181], v[180:181], v[10:11] op_sel_hi:[1,0]
    v_pk_mul_f32 v[182:183], v[182:183], v[10:11] op_sel_hi:[1,0]
    v_cvt_pk_bf16_f32 v176, v176, v177
    v_cvt_pk_bf16_f32 v177, v178, v179
    v_cvt_pk_bf16_f32 v178, v180, v181
    v_cvt_pk_bf16_f32 v179, v182, v183
    s_nop 1
    v_permlane16_swap_b32 v176, v178
    v_permlane16_swap_b32 v177, v179
    global_store_dwordx4 v9, v[176:179], s[30:31] offset:128 sc1
    v_pk_mul_f32 v[184:185], v[184:185], v[10:11] op_sel_hi:[1,0]
    v_pk_mul_f32 v[186:187], v[186:187], v[10:11] op_sel_hi:[1,0]
    v_pk_mul_f32 v[188:189], v[188:189], v[10:11] op_sel_hi:[1,0]
    v_pk_mul_f32 v[190:191], v[190:191], v[10:11] op_sel_hi:[1,0]
    v_cvt_pk_bf16_f32 v184, v184, v185
    v_cvt_pk_bf16_f32 v185, v186, v187
    v_cvt_pk_bf16_f32 v186, v188, v189
    v_cvt_pk_bf16_f32 v187, v190, v191
    s_nop 1
    v_permlane16_swap_b32 v184, v186
    v_permlane16_swap_b32 v185, v187
    global_store_dwordx4 v9, v[184:187], s[30:31] offset:192 sc1
    s_lshl_b32 s31, s12, 7
    s_add_u32 s31, s31, 0x7408000
    s_waitcnt vmcnt(0)
    s_barrier
    s_cmp_lg_u32 s10, 0
    s_cbranch_scc1 Lsg_61
    s_mov_b64 exec, 1
    v_mov_b32 v20, s31
    v_mov_b32 v21, 1
    global_atomic_add v20, v21, s[4:5]
    s_mov_b64 exec, -1
Lsg_61:
    s_add_u32 s12, s12, 4
    s_cmp_lt_u32 s12, 64
    s_cbranch_scc1 Lat_50
    s_branch Lroles_11
Lrwo_46:
    s_mul_hi_u32 s71, s64, 0x6666667
    s_mul_i32 s66, s71, 40
    s_sub_u32 s66, s64, s66
    s_and_b32 s70, s66, 7
    s_lshr_b32 s72, s66, 3
    s_load_dwordx2 s[40:41], s[0:1], 40
    s_waitcnt lgkmcnt(0)
    s_mul_i32 s16, s70, 655360
    s_lshl_b32 s17, s72, 8
    s_add_u32 s16, s16, s17
    s_add_u32 s46, s40, s16
    s_addc_u32 s47, s41, 0
    s_add_u32 s48, s46, 128
    s_addc_u32 s49, s47, 0
    v_lshrrev_b32 v12, 3, v2
    v_and_b32 v13, 7, v2
    v_bfe_u32 v14, v12, 1, 1
    v_lshlrev_b32 v14, 2, v14
    v_xor_b32 v14, v13, v14
    v_lshlrev_b32 v14, 4, v14
    s_and_b32 s20, s10, 1
    s_lshl_b32 s20, s20, 5
    v_add_u32 v15, s20, v12
    s_mov_b32 s21, 1280
    v_mul_lo_u32 v15, v15, s21
    v_add_u32 v8, v15, v14
    v_add_u32 v9, 10240, v8
    v_add_u32 v10, 20480, v8
    v_add_u32 v11, 30720, v8
    s_cmp_ge_u32 s10, 2
    s_cselect_b32 s22, s48, s46
    s_cselect_b32 s23, s49, s47
    s_lshl_b32 s26, s10, 12
    v_bfe_u32 v12, v2, 4, 1
    v_lshrrev_b32 v13, 5, v2
    v_bfe_u32 v14, v2, 2, 2
    v_and_b32 v15, 3, v2
    v_lshlrev_b32 v20, 3, v13
    v_add_u32 v20, v20, v14
    v_lshlrev_b32 v20, 7, v20
    v_lshrrev_b32 v22, 1, v15
    v_lshlrev_b32 v21, 1, v12
    v_add_u32 v21, v21, v22
    s_and_b32 s20, s10, 1
    s_lshl_b32 s20, s20, 2
    v_add_u32 v21, s20, v21
    s_lshr_b32 s20, s10, 1
    s_lshl_b32 s20, s20, 13
    v_add_u32 v20, s20, v20
    v_lshrrev_b32 v22, 1, v14
    v_lshlrev_b32 v22, 2, v22
    v_xor_b32 v21, v21, v22
    v_lshlrev_b32 v21, 4, v21
    v_and_b32 v22, 1, v15
    v_lshlrev_b32 v22, 3, v22
    v_add3_u32 v20, v20, v21, v22
    s_add_u32 m0, s26, 0
    s_nop 0
    global_load_lds_dwordx4 v8, s[22:23]
    s_add_u32 m0, s26, 1024
    s_nop 0
    global_load_lds_dwordx4 v9, s[22:23]
    s_add_u32 m0, s26, 2048
    s_nop 0
    global_load_lds_dwordx4 v10, s[22:23]
    s_add_u32 m0, s26, 3072
    s_nop 0
    global_load_lds_dwordx4 v11, s[22:23]
    s_add_u32 s22, s22, 81920
    s_addc_u32 s23, s23, 0
    s_add_u32 m0, s26, 16384
    s_nop 0
    global_load_lds_dwordx4 v8, s[22:23]
    s_add_u32 m0, s26, 17408
    s_nop 0
    global_load_lds_dwordx4 v9, s[22:23]
    s_add_u32 m0, s26, 18432
    s_nop 0
    global_load_lds_dwordx4 v10, s[22:23]
    s_add_u32 m0, s26, 19456
    s_nop 0
    global_load_lds_dwordx4 v11, s[22:23]
    s_add_u32 s22, s22, 81920
    s_addc_u32 s23, s23, 0
    s_add_u32 m0, s26, 32768
    s_nop 0
    global_load_lds_dwordx4 v8, s[22:23]
    s_add_u32 m0, s26, 33792
    s_nop 0
    global_load_lds_dwordx4 v9, s[22:23]
    s_add_u32 m0, s26, 34816
    s_nop 0
    global_load_lds_dwordx4 v10, s[22:23]
    s_add_u32 m0, s26, 35840
    s_nop 0
    global_load_lds_dwordx4 v11, s[22:23]
    s_add_u32 s22, s22, 81920
    s_addc_u32 s23, s23, 0
    s_waitcnt vmcnt(8)
    s_barrier
    s_add_u32 m0, s26, 49152
    s_nop 0
    global_load_lds_dwordx4 v8, s[22:23]
    s_add_u32 m0, s26, 50176
    s_nop 0
    global_load_lds_dwordx4 v9, s[22:23]
    s_add_u32 m0, s26, 51200
    s_nop 0
    global_load_lds_dwordx4 v10, s[22:23]
    s_add_u32 m0, s26, 52224
    s_nop 0
    global_load_lds_dwordx4 v11, s[22:23]
    s_add_u32 s22, s22, 81920
    s_addc_u32 s23, s23, 0
    ds_read_b64_tr_b16 a[0:1], v20 offset:0
    ds_read_b64_tr_b16 a[2:3], v20 offset:512
    ds_read_b64_tr_b16 a[4:5], v20 offset:2048
    ds_read_b64_tr_b16 a[6:7], v20 offset:2560
    ds_read_b64_tr_b16 a[8:9], v20 offset:4096
    ds_read_b64_tr_b16 a[10:11], v20 offset:4608
    ds_read_b64_tr_b16 a[12:13], v20 offset:6144
    ds_read_b64_tr_b16 a[14:15], v20 offset:6656
    s_waitcnt lgkmcnt(0)
    s_waitcnt vmcnt(8)
    s_barrier
    s_add_u32 m0, s26, 0
    s_nop 0
    global_load_lds_dwordx4 v8, s[22:23]
    s_add_u32 m0, s26, 1024
    s_nop 0
    global_load_lds_dwordx4 v9, s[22:23]
    s_add_u32 m0, s26, 2048
    s_nop 0
    global_load_lds_dwordx4 v10, s[22:23]
    s_add_u32 m0, s26, 3072
    s_nop 0
    global_load_lds_dwordx4 v11, s[22:23]
    s_add_u32 s22, s22, 81920
    s_addc_u32 s23, s23, 0
    ds_read_b64_tr_b16 a[16:17], v20 offset:16384
    ds_read_b64_tr_b16 a[18:19], v20 offset:16896
    ds_read_b64_tr_b16 a[20:21], v20 offset:18432
    ds_read_b64_tr_b16 a[22:23], v20 offset:18944
    ds_read_b64_tr_b16 a[24:25], v20 offset:20480
    ds_read_b64_tr_b16 a[26:27], v20 offset:20992
    ds_read_b64_tr_b16 a[28:29], v20 offset:22528
    ds_read_b64_tr_b16 a[30:31], v20 offset:23040
    s_waitcnt lgkmcnt(0)
    s_waitcnt vmcnt(8)
    s_barrier
    s_add_u32 m0, s26, 16384
    s_nop 0
    global_load_lds_dwordx4 v8, s[22:23]
    s_add_u32 m0, s26, 17408
    s_nop 0
    global_load_lds_dwordx4 v9, s[22:23]
    s_add_u32 m0, s26, 18432
    s_nop 0
    global_load_lds_dwordx4 v10, s[22:23]
    s_add_u32 m0, s26, 19456
    s_nop 0
    global_load_lds_dwordx4 v11, s[22:23]
    s_add_u32 s22, s22, 81920
    s_addc_u32 s23, s23, 0
    ds_read_b64_tr_b16 a[32:33], v20 offset:32768
    ds_read_b64_tr_b16 a[34:35], v20 offset:33280
    ds_read_b64_tr_b16 a[36:37], v20 offset:34816
    ds_read_b64_tr_b16 a[38:39], v20 offset:35328
    ds_read_b64_tr_b16 a[40:41], v20 offset:36864
    ds_read_b64_tr_b16 a[42:43], v20 offset:37376
    ds_read_b64_tr_b16 a[44:45], v20 offset:38912
    ds_read_b64_tr_b16 a[46:47], v20 offset:39424
    s_waitcnt lgkmcnt(0)
    s_waitcnt vmcnt(8)
    s_barrier
    s_add_u32 m0, s26, 32768
    s_nop 0
    global_load_lds_dwordx4 v8, s[22:23]
    s_add_u32 m0, s26, 33792
    s_nop 0
    global_load_lds_dwordx4 v9, s[22:23]
    s_add_u32 m0, s26, 34816
    s_nop 0
    global_load_lds_dwordx4 v10, s[22:23]
    s_add_u32 m0, s26, 35840
    s_nop 0
    global_load_lds_dwordx4 v11, s[22:23]
    s_add_u32 s22, s22, 81920
    s_addc_u32 s23, s23, 0
    ds_read_b64_tr_b16 a[48:49], v20 offset:49152
    ds_read_b64_tr_b16 a[50:51], v20 offset:49664
    ds_read_b64_tr_b16 a[52:53], v20 offset:51200
    ds_read_b64_tr_b16 a[54:55], v20 offset:51712
    ds_read_b64_tr_b16 a[56:57], v20 offset:53248
    ds_read_b64_tr_b16 a[58:59], v20 offset:53760
    ds_read_b64_tr_b16 a[60:61], v20 offset:55296
    ds_read_b64_tr_b16 a[62:63], v20 offset:55808
    s_waitcnt lgkmcnt(0)
    s_waitcnt vmcnt(8)
    s_barrier
    s_add_u32 m0, s26, 49152
    s_nop 0
    global_load_lds_dwordx4 v8, s[22:23]
    s_add_u32 m0, s26, 50176
    s_nop 0
    global_load_lds_dwordx4 v9, s[22:23]
    s_add_u32 m0, s26, 51200
    s_nop 0
    global_load_lds_dwordx4 v10, s[22:23]
    s_add_u32 m0, s26, 52224
    s_nop 0
    global_load_lds_dwordx4 v11, s[22:23]
    s_add_u32 s22, s22, 81920
    s_addc_u32 s23, s23, 0
    ds_read_b64_tr_b16 a[64:65], v20 offset:0
    ds_read_b64_tr_b16 a[66:67], v20 offset:512
    ds_read_b64_tr_b16 a[68:69], v20 offset:2048
    ds_read_b64_tr_b16 a[70:71], v20 offset:2560
    ds_read_b64_tr_b16 a[72:73], v20 offset:4096
    ds_read_b64_tr_b16 a[74:75], v20 offset:4608
    ds_read_b64_tr_b16 a[76:77], v20 offset:6144
    ds_read_b64_tr_b16 a[78:79], v20 offset:6656
    s_waitcnt lgkmcnt(0)
    s_waitcnt vmcnt(8)
    s_barrier
    ds_read_b64_tr_b16 a[80:81], v20 offset:16384
    ds_read_b64_tr_b16 a[82:83], v20 offset:16896
    ds_read_b64_tr_b16 a[84:85], v20 offset:18432
    ds_read_b64_tr_b16 a[86:87], v20 offset:18944
    ds_read_b64_tr_b16 a[88:89], v20 offset:20480
    ds_read_b64_tr_b16 a[90:91], v20 offset:20992
    ds_read_b64_tr_b16 a[92:93], v20 offset:22528
    ds_read_b64_tr_b16 a[94:95], v20 offset:23040
    s_waitcnt lgkmcnt(0)
    s_waitcnt vmcnt(4)
    s_barrier
    ds_read_b64_tr_b16 a[96:97], v20 offset:32768
    ds_read_b64_tr_b16 a[98:99], v20 offset:33280
    ds_read_b64_tr_b16 a[100:101], v20 offset:34816
    ds_read_b64_tr_b16 a[102:103], v20 offset:35328
    ds_read_b64_tr_b16 a[104:105], v20 offset:36864
    ds_read_b64_tr_b16 a[106:107], v20 offset:37376
    ds_read_b64_tr_b16 a[108:109], v20 offset:38912
    ds_read_b64_tr_b16 a[110:111], v20 offset:39424
    s_waitcnt lgkmcnt(0)
    s_waitcnt vmcnt(0)
    s_barrier
    ds_read_b64_tr_b16 a[112:113], v20 offset:49152
    ds_read_b64_tr_b16 a[114:115], v20 offset:49664
    ds_read_b64_tr_b16 a[116:117], v20 offset:51200
    ds_read_b64_tr_b16 a[118:119], v20 offset:51712
    ds_read_b64_tr_b16 a[120:121], v20 offset:53248
    ds_read_b64_tr_b16 a[122:123], v20 offset:53760
    ds_read_b64_tr_b16 a[124:125], v20 offset:55296
    ds_read_b64_tr_b16 a[126:127], v20 offset:55808
    s_waitcnt lgkmcnt(0)
    s_barrier
    s_mov_b32 s20, 0x4000000
    s_mov_b32 s21, 8192
    s_lshl_b32 s24, s10, 6
    s_add_u32 s24, s24, 0
    v_add_u32 v12, s24, v2
    v_mul_hi_u32 v13, v12, s20
    v_mul_u32_u24 v14, 64, v13
    v_sub_u32 v14, v12, v14
    v_and_b32 v15, 7, v13
    v_xor_b32 v14, v14, v15
    v_lshlrev_b32 v14, 4, v14
    v_mul_lo_u32 v13, v13, s21
    v_add_u32 v40, v13, v14
    s_lshl_b32 s24, s10, 6
    s_add_u32 s24, s24, 256
    v_add_u32 v12, s24, v2
    v_mul_hi_u32 v13, v12, s20
    v_mul_u32_u24 v14, 64, v13
    v_sub_u32 v14, v12, v14
    v_and_b32 v15, 7, v13
    v_xor_b32 v14, v14, v15
    v_lshlrev_b32 v14, 4, v14
    v_mul_lo_u32 v13, v13, s21
    v_add_u32 v41, v13, v14
    s_lshl_b32 s24, s10, 6
    s_add_u32 s24, s24, 512
    v_add_u32 v12, s24, v2
    v_mul_hi_u32 v13, v12, s20
    v_mul_u32_u24 v14, 64, v13
    v_sub_u32 v14, v12, v14
    v_and_b32 v15, 7, v13
    v_xor_b32 v14, v14, v15
    v_lshlrev_b32 v14, 4, v14
    v_mul_lo_u32 v13, v13, s21
    v_add_u32 v42, v13, v14
    s_lshl_b32 s24, s10, 6
    s_add_u32 s24, s24, 768
    v_add_u32 v12, s24, v2
    v_mul_hi_u32 v13, v12, s20
    v_mul_u32_u24 v14, 64, v13
    v_sub_u32 v14, v12, v14
    v_and_b32 v15, 7, v13
    v_xor_b32 v14, v14, v15
    v_lshlrev_b32 v14, 4, v14
    v_mul_lo_u32 v13, v13, s21
    v_add_u32 v43, v13, v14
    s_lshl_b32 s24, s10, 6
    s_add_u32 s24, s24, 1024
    v_add_u32 v12, s24, v2
    v_mul_hi_u32 v13, v12, s20
    v_mul_u32_u24 v14, 64, v13
    v_sub_u32 v14, v12, v14
    v_and_b32 v15, 7, v13
    v_xor_b32 v14, v14, v15
    v_lshlrev_b32 v14, 4, v14
    v_mul_lo_u32 v13, v13, s21
    v_add_u32 v44, v13, v14
    s_lshl_b32 s24, s10, 6
    s_add_u32 s24, s24, 1280
    v_add_u32 v12, s24, v2
    v_mul_hi_u32 v13, v12, s20
    v_mul_u32_u24 v14, 64, v13
    v_sub_u32 v14, v12, v14
    v_and_b32 v15, 7, v13
    v_xor_b32 v14, v14, v15
    v_lshlrev_b32 v14, 4, v14
    v_mul_lo_u32 v13, v13, s21
    v_add_u32 v45, v13, v14
    s_lshl_b32 s24, s10, 6
    s_add_u32 s24, s24, 1536
    v_add_u32 v12, s24, v2
    v_mul_hi_u32 v13, v12, s20
    v_mul_u32_u24 v14, 64, v13
    v_sub_u32 v14, v12, v14
    v_and_b32 v15, 7, v13
    v_xor_b32 v14, v14, v15
    v_lshlrev_b32 v14, 4, v14
    v_mul_lo_u32 v13, v13, s21
    v_add_u32 v46, v13, v14
    s_lshl_b32 s24, s10, 6
    s_add_u32 s24, s24, 1792
    v_add_u32 v12, s24, v2
    v_mul_hi_u32 v13, v12, s20
    v_mul_u32_u24 v14, 64, v13
    v_sub_u32 v14, v12, v14
    v_and_b32 v15, 7, v13
    v_xor_b32 v14, v14, v15
    v_lshlrev_b32 v14, 4, v14
    v_mul_lo_u32 v13, v13, s21
    v_add_u32 v47, v13, v14
    v_and_b32 v12, 31, v2
    v_mul_u32_u24 v12, 1024, v12
    v_lshrrev_b32 v13, 5, v2
    v_and_b32 v14, 7, v2
    v_xor_b32 v13, v13, v14
    v_lshlrev_b32 v13, 4, v13
    v_add_u32 v52, v12, v13
    v_xor_b32 v53, 32, v52
    v_xor_b32 v54, 64, v52
    v_xor_b32 v55, 96, v52
    v_lshrrev_b32 v12, 5, v2
    v_mul_u32_u24 v12, 10240, v12
    v_and_b32 v13, 31, v2
    v_lshlrev_b32 v13, 2, v13
    s_lshl_b32 s20, s72, 9
    s_lshl_b32 s21, s10, 7
    s_add_u32 s20, s20, s21
    v_add3_u32 v56, v12, v13, s20
    s_mov_b32 s12, s71
Lwo_62:
    s_lshl_b32 s31, s12, 7
    s_add_u32 s31, s31, 0x7408000
    s_cmp_lg_u32 s10, 0
    s_cbranch_scc1 Ldw_63
    v_mov_b32 v20, s31
Lq_66:
    global_load_dword v21, v20, s[4:5] sc1
    s_waitcnt vmcnt(0)
    v_readfirstlane_b32 s62, v21
    s_nop 3
    s_cmp_ge_u32 s62, 8
    s_cbranch_scc1 Lqo_67
    s_sleep 2
    s_sub_u32 s63, s63, 1
    s_cbranch_scc0 Lq_66
    s_branch Ldf_64
Lqo_67:
    v_mov_b32 v21, 0
    s_branch Ldr_65
Ldf_64:
    v_mov_b32 v21, 1
Ldr_65:
    v_mov_b32 v20, 159760
    ds_write_b32 v20, v21
    s_waitcnt lgkmcnt(0)
Ldw_63:
    s_barrier
    v_mov_b32 v20, 159760
    ds_read_b32 v21, v20
    s_waitcnt lgkmcnt(0)
    v_readfirstlane_b32 s62, v21
    s_nop 3
    s_cmp_lg_u32 s62, 0
    s_cbranch_scc1 Lendf_3
    s_lshl_b32 s16, s12, 18
    s_lshl_b32 s17, s70, 10
    s_add_u32 s16, s16, s17
    s_add_u32 s50, s4, 0x4400000
    s_addc_u32 s51, s5, 0
    s_add_u32 s50, s50, s16
    s_addc_u32 s51, s51, 0
    s_lshl_b32 s24, s10, 10
    s_add_u32 m0, s24, 0
    s_nop 0
    global_load_lds_dwordx4 v40, s[50:51] sc1
    s_lshl_b32 s24, s10, 10
    s_add_u32 m0, s24, 4096
    s_nop 0
    global_load_lds_dwordx4 v41, s[50:51] sc1
    s_lshl_b32 s24, s10, 10
    s_add_u32 m0, s24, 8192
    s_nop 0
    global_load_lds_dwordx4 v42, s[50:51] sc1
    s_lshl_b32 s24, s10, 10
    s_add_u32 m0, s24, 12288
    s_nop 0
    global_load_lds_dwordx4 v43, s[50:51] sc1
    s_lshl_b32 s24, s10, 10
    s_add_u32 m0, s24, 16384
    s_nop 0
    global_load_lds_dwordx4 v44, s[50:51] sc1
    s_lshl_b32 s24, s10, 10
    s_add_u32 m0, s24, 20480
    s_nop 0
    global_load_lds_dwordx4 v45, s[50:51] sc1
    s_lshl_b32 s24, s10, 10
    s_add_u32 m0, s24, 24576
    s_nop 0
    global_load_lds_dwordx4 v46, s[50:51] sc1
    s_lshl_b32 s24, s10, 10
    s_add_u32 m0, s24, 28672
    s_nop 0
    global_load_lds_dwordx4 v47, s[50:51] sc1
    s_waitcnt vmcnt(0)
    s_barrier
    ds_read_b128 v[80:83], v52 offset:0
    ds_read_b128 v[84:87], v53 offset:0
    ds_read_b128 v[88:91], v54 offset:0
    ds_read_b128 v[92:95], v55 offset:0
    s_waitcnt lgkmcnt(3)
    v_mfma_f32_32x32x16_bf16 v[64:79], v[80:83], a[0:3], 0
    ds_read_b128 v[80:83], v52 offset:128
    s_waitcnt lgkmcnt(3)
    v_mfma_f32_32x32x16_bf16 v[64:79], v[84:87], a[4:7], v[64:79]
    ds_read_b128 v[84:87], v53 offset:128
    s_waitcnt lgkmcnt(3)
    v_mfma_f32_32x32x16_bf16 v[64:79], v[88:91], a[8:11], v[64:79]
    ds_read_b128 v[88:91], v54 offset:128
    s_waitcnt lgkmcnt(3)
    v_mfma_f32_32x32x16_bf16 v[64:79], v[92:95], a[12:15], v[64:79]
    ds_read_b128 v[92:95], v55 offset:128
    s_waitcnt lgkmcnt(3)
    v_mfma_f32_32x32x16_bf16 v[64:79], v[80:83], a[16:19], v[64:79]
    ds_read_b128 v[80:83], v52 offset:256
    s_waitcnt lgkmcnt(3)
    v_mfma_f32_32x32x16_bf16 v[64:79], v[84:87], a[20:23], v[64:79]
    ds_read_b128 v[84:87], v53 offset:256
    s_waitcnt lgkmcnt(3)
    v_mfma_f32_32x32x16_bf16 v[64:79], v[88:91], a[24:27], v[64:79]
    ds_read_b128 v[88:91], v54 offset:256
    s_waitcnt lgkmcnt(3)
    v_mfma_f32_32x32x16_bf16 v[64:79], v[92:95], a[28:31], v[64:79]
    ds_read_b128 v[92:95], v55 offset:256
    s_waitcnt lgkmcnt(3)
    v_mfma_f32_32x32x16_bf16 v[64:79], v[80:83], a[32:35], v[64:79]
    ds_read_b128 v[80:83], v52 offset:384
    s_waitcnt lgkmcnt(3)
    v_mfma_f32_32x32x16_bf16 v[64:79], v[84:87], a[36:39], v[64:79]
    ds_read_b128 v[84:87], v53 offset:384
    s_waitcnt lgkmcnt(3)
    v_mfma_f32_32x32x16_bf16 v[64:79], v[88:91], a[40:43], v[64:79]
    ds_read_b128 v[88:91], v54 offset:384
    s_waitcnt lgkmcnt(3)
    v_mfma_f32_32x32x16_bf16 v[64:79], v[92:95], a[44:47], v[64:79]
    ds_read_b128 v[92:95], v55 offset:384
    s_waitcnt lgkmcnt(3)
    v_mfma_f32_32x32x16_bf16 v[64:79], v[80:83], a[48:51], v[64:79]
    ds_read_b128 v[80:83], v52 offset:512
    s_waitcnt lgkmcnt(3)
    v_mfma_f32_32x32x16_bf16 v[64:79], v[84:87], a[52:55], v[64:79]
    ds_read_b128 v[84:87], v53 offset:512
    s_waitcnt lgkmcnt(3)
    v_mfma_f32_32x32x16_bf16 v[64:79], v[88:91], a[56:59], v[64:79]
    ds_read_b128 v[88:91], v54 offset:512
    s_waitcnt lgkmcnt(3)
    v_mfma_f32_32x32x16_bf16 v[64:79], v[92:95], a[60:63], v[64:79]
    ds_read_b128 v[92:95], v55 offset:512
    s_waitcnt lgkmcnt(3)
    v_mfma_f32_32x32x16_bf16 v[64:79], v[80:83], a[64:67], v[64:79]
    ds_read_b128 v[80:83], v52 offset:640
    s_waitcnt lgkmcnt(3)
    v_mfma_f32_32x32x16_bf16 v[64:79], v[84:87], a[68:71], v[64:79]
    ds_read_b128 v[84:87], v53 offset:640
    s_waitcnt lgkmcnt(3)
    v_mfma_f32_32x32x16_bf16 v[64:79], v[88:91], a[72:75], v[64:79]
    ds_read_b128 v[88:91], v54 offset:640
    s_waitcnt lgkmcnt(3)
    v_mfma_f32_32x32x16_bf16 v[64:79], v[92:95], a[76:79], v[64:79]
    ds_read_b128 v[92:95], v55 offset:640
    s_waitcnt lgkmcnt(3)
    v_mfma_f32_32x32x16_bf16 v[64:79], v[80:83], a[80:83], v[64:79]
    ds_read_b128 v[80:83], v52 offset:768
    s_waitcnt lgkmcnt(3)
    v_mfma_f32_32x32x16_bf16 v[64:79], v[84:87], a[84:87], v[64:79]
    ds_read_b128 v[84:87], v53 offset:768
    s_waitcnt lgkmcnt(3)
    v_mfma_f32_32x32x16_bf16 v[64:79], v[88:91], a[88:91], v[64:79]
    ds_read_b128 v[88:91], v54 offset:768
    s_waitcnt lgkmcnt(3)
    v_mfma_f32_32x32x16_bf16 v[64:79], v[92:95], a[92:95], v[64:79]
    ds_read_b128 v[92:95], v55 offset:768
    s_waitcnt lgkmcnt(3)
    v_mfma_f32_32x32x16_bf16 v[64:79], v[80:83], a[96:99], v[64:79]
    ds_read_b128 v[80:83], v52 offset:896
    s_waitcnt lgkmcnt(3)
    v_mfma_f32_32x32x16_bf16 v[64:79], v[84:87], a[100:103], v[64:79]
    ds_read_b128 v[84:87], v53 offset:896
    s_waitcnt lgkmcnt(3)
    v_mfma_f32_32x32x16_bf16 v[64:79], v[88:91], a[104:107], v[64:79]
    ds_read_b128 v[88:91], v54 offset:896
    s_waitcnt lgkmcnt(3)
    v_mfma_f32_32x32x16_bf16 v[64:79], v[92:95], a[108:111], v[64:79]
    ds_read_b128 v[92:95], v55 offset:896
    s_waitcnt lgkmcnt(3)
    v_mfma_f32_32x32x16_bf16 v[64:79], v[80:83], a[112:115], v[64:79]
    s_waitcnt lgkmcnt(2)
    v_mfma_f32_32x32x16_bf16 v[64:79], v[84:87], a[116:119], v[64:79]
    s_waitcnt lgkmcnt(1)
    v_mfma_f32_32x32x16_bf16 v[64:79], v[88:91], a[120:123], v[64:79]
    s_waitcnt lgkmcnt(0)
    v_mfma_f32_32x32x16_bf16 v[64:79], v[92:95], a[124:127], v[64:79]
    s_nop 15
    s_mul_i32 s16, s12, 81920
    s_add_u32 s54, s4, 0x7800000
    s_addc_u32 s55, s5, 0
    s_add_u32 s54, s54, s16
    s_addc_u32 s55, s55, 0
    v_add_u32 v12, 0, v56
    global_atomic_add_f32 v12, v64, s[54:55]
    v_add_u32 v12, 2560, v56
    global_atomic_add_f32 v12, v65, s[54:55]
    v_add_u32 v12, 5120, v56
    global_atomic_add_f32 v12, v66, s[54:55]
    v_add_u32 v12, 7680, v56
    global_atomic_add_f32 v12, v67, s[54:55]
    v_add_u32 v12, 20480, v56
    global_atomic_add_f32 v12, v68, s[54:55]
    v_add_u32 v12, 23040, v56
    global_atomic_add_f32 v12, v69, s[54:55]
    v_add_u32 v12, 25600, v56
    global_atomic_add_f32 v12, v70, s[54:55]
    v_add_u32 v12, 28160, v56
    global_atomic_add_f32 v12, v71, s[54:55]
    v_add_u32 v12, 40960, v56
    global_atomic_add_f32 v12, v72, s[54:55]
    v_add_u32 v12, 43520, v56
    global_atomic_add_f32 v12, v73, s[54:55]
    v_add_u32 v12, 46080, v56
    global_atomic_add_f32 v12, v74, s[54:55]
    v_add_u32 v12, 48640, v56
    global_atomic_add_f32 v12, v75, s[54:55]
    v_add_u32 v12, 61440, v56
    global_atomic_add_f32 v12, v76, s[54:55]
    v_add_u32 v12, 64000, v56
    global_atomic_add_f32 v12, v77, s[54:55]
    v_add_u32 v12, 66560, v56
    global_atomic_add_f32 v12, v78, s[54:55]
    v_add_u32 v12, 69120, v56
    global_atomic_add_f32 v12, v79, s[54:55]
    s_add_u32 s31, s31, 4
    s_waitcnt vmcnt(0)
    s_barrier
    s_cmp_lg_u32 s10, 0
    s_cbranch_scc1 Lsg_68
    s_mov_b64 exec, 1
    v_mov_b32 v20, s31
    v_mov_b32 v21, 1
    global_atomic_add v20, v21, s[4:5]
    s_mov_b64 exec, -1
Lsg_68:
    s_add_u32 s12, s12, 2
    s_cmp_lt_u32 s12, 64
    s_cbranch_scc1 Lwo_62
    s_branch Lroles_11
Lrln_49:
    s_and_b32 s70, s64, 3
    s_lshr_b32 s71, s64, 2
    s_load_dwordx2 s[40:41], s[0:1], 0
    s_add_u32 s42, s4, 0x7800000
    s_addc_u32 s43, s5, 0
    s_add_u32 s44, s4, 0x5400000
    s_addc_u32 s45, s5, 0
    s_add_u32 s46, s4, 0x5800000
    s_addc_u32 s47, s5, 0
    v_lshrrev_b32 v12, 5, v2
    v_and_b32 v13, 31, v2
    s_lshl_b32 s20, s70, 3
    s_lshl_b32 s21, s10, 1
    s_add_u32 s20, s20, s21
    v_add_u32 v12, s20, v12
    v_mul_u32_u24 v14, 2560, v12
    v_lshlrev_b32 v15, 4, v13
    v_add_u32 v14, v14, v15
    v_mul_u32_u24 v16, 1280, v12
    v_lshlrev_b32 v15, 3, v13
    v_add_u32 v16, v16, v15
    s_waitcnt lgkmcnt(0)
    s_mov_b32 s12, s71
Lln_69:
    s_mul_i32 s16, s12, 40960
    s_mul_i32 s17, s12, 81920
    s_add_u32 s50, s40, s16
    s_addc_u32 s51, s41, 0
    s_add_u32 s52, s42, s17
    s_addc_u32 s53, s43, 0
    s_add_u32 s54, s44, s16
    s_addc_u32 s55, s45, 0
    s_add_u32 s56, s46, s16
    s_addc_u32 s57, s47, 0
    global_load_dwordx2 v[60:61], v16, s[50:51] offset:0
    global_load_dwordx2 v[62:63], v16, s[50:51] offset:256
    global_load_dwordx2 v[64:65], v16, s[50:51] offset:512
    global_load_dwordx2 v[66:67], v16, s[50:51] offset:768
    global_load_dwordx2 v[68:69], v16, s[50:51] offset:1024
    s_lshl_b32 s31, s12, 7
    s_add_u32 s31, s31, 0x7408004
    s_cmp_lg_u32 s10, 0
    s_cbranch_scc1 Ldw_70
    v_mov_b32 v20, s31
Lq_73:
    global_load_dword v21, v20, s[4:5] sc1
    s_waitcnt vmcnt(0)
    v_readfirstlane_b32 s62, v21
    s_nop 3
    s_cmp_ge_u32 s62, 40
    s_cbranch_scc1 Lqo_74
    s_sleep 2
    s_sub_u32 s63, s63, 1
    s_cbranch_scc0 Lq_73
    s_branch Ldf_71
Lqo_74:
    v_mov_b32 v21, 0
    s_branch Ldr_72
Ldf_71:
    v_mov_b32 v21, 1
Ldr_72:
    v_mov_b32 v20, 159760
    ds_write_b32 v20, v21
    s_waitcnt lgkmcnt(0)
Ldw_70:
    s_barrier
    v_mov_b32 v20, 159760
    ds_read_b32 v21, v20
    s_waitcnt lgkmcnt(0)
    v_readfirstlane_b32 s62, v21
    s_nop 3
    s_cmp_lg_u32 s62, 0
    s_cbranch_scc1 Lendf_3
    global_load_dwordx4 v[40:43], v14, s[52:53] offset:0 sc1
    global_load_dwordx4 v[44:47], v14, s[52:53] offset:512 sc1
    global_load_dwordx4 v[48:51], v14, s[52:53] offset:1024 sc1
    global_load_dwordx4 v[52:55], v14, s[52:53] offset:1536 sc1
    global_load_dwordx4 v[56:59], v14, s[52:53] offset:2048 sc1
    s_waitcnt vmcnt(0)
    v_cvt_pk_bf16_f32 v20, v40, v41
    v_lshlrev_b32 v21, 16, v20
    v_and_b32 v22, 0xffff0000, v20
    v_lshlrev_b32 v23, 16, v60
    v_and_b32 v24, 0xffff0000, v60
    v_add_f32 v21, v21, v23
    v_add_f32 v22, v22, v24
    v_cvt_pk_bf16_f32 v60, v21, v22
    v_lshlrev_b32 v40, 16, v60
    v_and_b32 v41, 0xffff0000, v60
    v_cvt_pk_bf16_f32 v20, v42, v43
    v_lshlrev_b32 v21, 16, v20
    v_and_b32 v22, 0xffff0000, v20
    v_lshlrev_b32 v23, 16, v61
    v_and_b32 v24, 0xffff0000, v61
    v_add_f32 v21, v21, v23
    v_add_f32 v22, v22, v24
    v_cvt_pk_bf16_f32 v61, v21, v22
    v_lshlrev_b32 v42, 16, v61
    v_and_b32 v43, 0xffff0000, v61
    v_cvt_pk_bf16_f32 v20, v44, v45
    v_lshlrev_b32 v21, 16, v20
    v_and_b32 v22, 0xffff0000, v20
    v_lshlrev_b32 v23, 16, v62
    v_and_b32 v24, 0xffff0000, v62
    v_add_f32 v21, v21, v23
    v_add_f32 v22, v22, v24
    v_cvt_pk_bf16_f32 v62, v21, v22
    v_lshlrev_b32 v44, 16, v62
    v_and_b32 v45, 0xffff0000, v62
    v_cvt_pk_bf16_f32 v20, v46, v47
    v_lshlrev_b32 v21, 16, v20
    v_and_b32 v22, 0xffff0000, v20
    v_lshlrev_b32 v23, 16, v63
    v_and_b32 v24, 0xffff0000, v63
    v_add_f32 v21, v21, v23
    v_add_f32 v22, v22, v24
    v_cvt_pk_bf16_f32 v63, v21, v22
    v_lshlrev_b32 v46, 16, v63
    v_and_b32 v47, 0xffff0000, v63
    v_cvt_pk_bf16_f32 v20, v48, v49
    v_lshlrev_b32 v21, 16, v20
    v_and_b32 v22, 0xffff0000, v20
    v_lshlrev_b32 v23, 16, v64
    v_and_b32 v24, 0xffff0000, v64
    v_add_f32 v21, v21, v23
    v_add_f32 v22, v22, v24
    v_cvt_pk_bf16_f32 v64, v21, v22
    v_lshlrev_b32 v48, 16, v64
    v_and_b32 v49, 0xffff0000, v64
    v_cvt_pk_bf16_f32 v20, v50, v51
    v_lshlrev_b32 v21, 16, v20
    v_and_b32 v22, 0xffff0000, v20
    v_lshlrev_b32 v23, 16, v65
    v_and_b32 v24, 0xffff0000, v65
    v_add_f32 v21, v21, v23
    v_add_f32 v22, v22, v24
    v_cvt_pk_bf16_f32 v65, v21, v22
    v_lshlrev_b32 v50, 16, v65
    v_and_b32 v51, 0xffff0000, v65
    v_cvt_pk_bf16_f32 v20, v52, v53
    v_lshlrev_b32 v21, 16, v20
    v_and_b32 v22, 0xffff0000, v20
    v_lshlrev_b32 v23, 16, v66
    v_and_b32 v24, 0xffff0000, v66
    v_add_f32 v21, v21, v23
    v_add_f32 v22, v22, v24
    v_cvt_pk_bf16_f32 v66, v21, v22
    v_lshlrev_b32 v52, 16, v66
    v_and_b32 v53, 0xffff0000, v66
    v_cvt_pk_bf16_f32 v20, v54, v55
    v_lshlrev_b32 v21, 16, v20
    v_and_b32 v22, 0xffff0000, v20
    v_lshlrev_b32 v23, 16, v67
    v_and_b32 v24, 0xffff0000, v67
    v_add_f32 v21, v21, v23
    v_add_f32 v22, v22, v24
    v_cvt_pk_bf16_f32 v67, v21, v22
    v_lshlrev_b32 v54, 16, v67
    v_and_b32 v55, 0xffff0000, v67
    v_cvt_pk_bf16_f32 v20, v56, v57
    v_lshlrev_b32 v21, 16, v20
    v_and_b32 v22, 0xffff0000, v20
    v_lshlrev_b32 v23, 16, v68
    v_and_b32 v24, 0xffff0000, v68
    v_add_f32 v21, v21, v23
    v_add_f32 v22, v22, v24
    v_cvt_pk_bf16_f32 v68, v21, v22
    v_lshlrev_b32 v56, 16, v68
    v_and_b32 v57, 0xffff0000, v68
    v_cvt_pk_bf16_f32 v20, v58, v59
    v_lshlrev_b32 v21, 16, v20
    v_and_b32 v22, 0xffff0000, v20
    v_lshlrev_b32 v23, 16, v69
    v_and_b32 v24, 0xffff0000, v69
    v_add_f32 v21, v21, v23
    v_add_f32 v22, v22, v24
    v_cvt_pk_bf16_f32 v69, v21, v22
    v_lshlrev_b32 v58, 16, v69
    v_and_b32 v59, 0xffff0000, v69
    global_store_dwordx2 v16, v[60:61], s[54:55] offset:0 sc1
    global_store_dwordx2 v16, v[62:63], s[54:55] offset:256 sc1
    global_store_dwordx2 v16, v[64:65], s[54:55] offset:512 sc1
    global_store_dwordx2 v16, v[66:67], s[54:55] offset:768 sc1
    global_store_dwordx2 v16, v[68:69], s[54:55] offset:1024 sc1
    v_add_f32 v20, v40, v41
    v_add_f32 v21, v42, v43
    v_add_f32 v20, v20, v44
    v_add_f32 v21, v21, v45
    v_add_f32 v20, v20, v46
    v_add_f32 v21, v21, v47
    v_add_f32 v20, v20, v48
    v_add_f32 v21, v21, v49
    v_add_f32 v20, v20, v50
    v_add_f32 v21, v21, v51
    v_add_f32 v20, v20, v52
    v_add_f32 v21, v21, v53
    v_add_f32 v20, v20, v54
    v_add_f32 v21, v21, v55
    v_add_f32 v20, v20, v56
    v_add_f32 v21, v21, v57
    v_add_f32 v20, v20, v58
    v_add_f32 v21, v21, v59
    v_add_f32 v20, v20, v21
    s_nop 1
    v_add_f32_dpp v20, v20, v20 quad_perm:[1,0,3,2] row_mask:0xf bank_mask:0xf
    s_nop 1
    v_add_f32_dpp v20, v20, v20 quad_perm:[2,3,0,1] row_mask:0xf bank_mask:0xf
    s_nop 1
    v_add_f32_dpp v20, v20, v20 row_half_mirror row_mask:0xf bank_mask:0xf
    s_nop 1
    v_add_f32_dpp v20, v20, v20 row_mirror row_mask:0xf bank_mask:0xf
    v_mov_b32 v25, v20
    s_nop 1
    v_permlane16_swap_b32 v20, v25
    v_add_f32 v20, v20, v25
    v_mul_f32 v20, 0x3acccccd, v20
    v_sub_f32 v40, v40, v20
    v_sub_f32 v41, v41, v20
    v_sub_f32 v42, v42, v20
    v_sub_f32 v43, v43, v20
    v_sub_f32 v44, v44, v20
    v_sub_f32 v45, v45, v20
    v_sub_f32 v46, v46, v20
    v_sub_f32 v47, v47, v20
    v_sub_f32 v48, v48, v20
    v_sub_f32 v49, v49, v20
    v_sub_f32 v50, v50, v20
    v_sub_f32 v51, v51, v20
    v_sub_f32 v52, v52, v20
    v_sub_f32 v53, v53, v20
    v_sub_f32 v54, v54, v20
    v_sub_f32 v55, v55, v20
    v_sub_f32 v56, v56, v20
    v_sub_f32 v57, v57, v20
    v_sub_f32 v58, v58, v20
    v_sub_f32 v59, v59, v20
    v_mul_f32 v21, v40, v40
    v_mul_f32 v22, v41, v41
    v_fmac_f32 v21, v42, v42
    v_fmac_f32 v22, v43, v43
    v_fmac_f32 v21, v44, v44
    v_fmac_f32 v22, v45, v45
    v_fmac_f32 v21, v46, v46
    v_fmac_f32 v22, v47, v47
    v_fmac_f32 v21, v48, v48
    v_fmac_f32 v22, v49, v49
    v_fmac_f32 v21, v50, v50
    v_fmac_f32 v22, v51, v51
    v_fmac_f32 v21, v52, v52
    v_fmac_f32 v22, v53, v53
    v_fmac_f32 v21, v54, v54
    v_fmac_f32 v22, v55, v55
    v_fmac_f32 v21, v56, v56
    v_fmac_f32 v22, v57, v57
    v_fmac_f32 v21, v58, v58
    v_fmac_f32 v22, v59, v59
    v_add_f32 v21, v21, v22
    s_nop 1
    v_add_f32_dpp v21, v21, v21 quad_perm:[1,0,3,2] row_mask:0xf bank_mask:0xf
    s_nop 1
    v_add_f32_dpp v21, v21, v21 quad_perm:[2,3,0,1] row_mask:0xf bank_mask:0xf
    s_nop 1
    v_add_f32_dpp v21, v21, v21 row_half_mirror row_mask:0xf bank_mask:0xf
    s_nop 1
    v_add_f32_dpp v21, v21, v21 row_mirror row_mask:0xf bank_mask:0xf
    v_mov_b32 v25, v21
    s_nop 1
    v_permlane16_swap_b32 v21, v25
    v_add_f32 v21, v21, v25
    v_mov_b32 v22, 0x3727c5ac
    v_fmac_f32 v22, 0x3acccccd, v21
    v_rsq_f32 v22, v22
    s_nop 0
    v_mul_f32 v40, v40, v22
    v_mul_f32 v41, v41, v22
    v_mul_f32 v42, v42, v22
    v_mul_f32 v43, v43, v22
    v_mul_f32 v44, v44, v22
    v_mul_f32 v45, v45, v22
    v_mul_f32 v46, v46, v22
    v_mul_f32 v47, v47, v22
    v_mul_f32 v48, v48, v22
    v_mul_f32 v49, v49, v22
    v_mul_f32 v50, v50, v22
    v_mul_f32 v51, v51, v22
    v_mul_f32 v52, v52, v22
    v_mul_f32 v53, v53, v22
    v_mul_f32 v54, v54, v22
    v_mul_f32 v55, v55, v22
    v_mul_f32 v56, v56, v22
    v_mul_f32 v57, v57, v22
    v_mul_f32 v58, v58, v22
    v_mul_f32 v59, v59, v22
    v_cvt_pk_bf16_f32 v70, v40, v41
    v_cvt_pk_bf16_f32 v71, v42, v43
    v_cvt_pk_bf16_f32 v72, v44, v45
    v_cvt_pk_bf16_f32 v73, v46, v47
    v_cvt_pk_bf16_f32 v74, v48, v49
    v_cvt_pk_bf16_f32 v75, v50, v51
    v_cvt_pk_bf16_f32 v76, v52, v53
    v_cvt_pk_bf16_f32 v77, v54, v55
    v_cvt_pk_bf16_f32 v78, v56, v57
    v_cvt_pk_bf16_f32 v79, v58, v59
    global_store_dwordx2 v16, v[70:71], s[56:57] offset:0 sc1
    global_store_dwordx2 v16, v[72:73], s[56:57] offset:256 sc1
    global_store_dwordx2 v16, v[74:75], s[56:57] offset:512 sc1
    global_store_dwordx2 v16, v[76:77], s[56:57] offset:768 sc1
    global_store_dwordx2 v16, v[78:79], s[56:57] offset:1024 sc1
    s_add_u32 s31, s31, 4
    s_waitcnt vmcnt(0)
    s_barrier
    s_cmp_lg_u32 s10, 0
    s_cbranch_scc1 Lsg_75
    s_mov_b64 exec, 1
    v_mov_b32 v20, s31
    v_mov_b32 v21, 1
    global_atomic_add v20, v21, s[4:5]
    s_mov_b64 exec, -1
Lsg_75:
    s_add_u32 s12, s12, 3
    s_cmp_lt_u32 s12, 64
    s_cbranch_scc1 Lln_69
    s_branch Lroles_11
Lrgu_47:
    s_mul_hi_u32 s71, s64, 0x97b425f
    s_mul_i32 s70, s71, 27
    s_sub_u32 s70, s64, s70
    s_load_dwordx2 s[40:41], s[0:1], 64
    s_load_dwordx2 s[42:43], s[0:1], 72
    s_waitcnt lgkmcnt(0)
    s_lshl_b32 s16, s70, 7
    s_add_u32 s46, s40, s16
    s_addc_u32 s47, s41, 0
    s_add_u32 s48, s42, s16
    s_addc_u32 s49, s43, 0
    v_lshrrev_b32 v12, 3, v2
    v_and_b32 v13, 7, v2
    v_bfe_u32 v14, v12, 1, 1
    v_lshlrev_b32 v14, 2, v14
    v_xor_b32 v14, v13, v14
    v_lshlrev_b32 v14, 4, v14
    s_and_b32 s20, s10, 1
    s_lshl_b32 s20, s20, 5
    v_add_u32 v15, s20, v12
    s_mov_b32 s21, 3456
    v_mul_lo_u32 v15, v15, s21
    v_add_u32 v8, v15, v14
    v_add_u32 v9, 27648, v8
    v_add_u32 v10, 55296, v8
    v_add_u32 v11, 82944, v8
    s_cmp_ge_u32 s10, 2
    s_cselect_b32 s22, s48, s46
    s_cselect_b32 s23, s49, s47
    s_lshl_b32 s26, s10, 12
    v_bfe_u32 v12, v2, 4, 1
    v_lshrrev_b32 v13, 5, v2
    v_bfe_u32 v14, v2, 2, 2
    v_and_b32 v15, 3, v2
    v_lshlrev_b32 v20, 3, v13
    v_add_u32 v20, v20, v14
    v_lshlrev_b32 v20, 7, v20
    v_lshrrev_b32 v22, 1, v15
    s_lshl_b32 s20, s10, 1
    v_add_u32 v21, s20, v22
    v_lshlrev_b32 v23, 13, v12
    v_add_u32 v20, v20, v23
    v_lshrrev_b32 v22, 1, v14
    v_lshlrev_b32 v22, 2, v22
    v_xor_b32 v21, v21, v22
    v_lshlrev_b32 v21, 4, v21
    v_and_b32 v22, 1, v15
    v_lshlrev_b32 v22, 3, v22
    v_add3_u32 v20, v20, v21, v22
    s_add_u32 m0, s26, 0
    s_nop 0
    global_load_lds_dwordx4 v8, s[22:23]
    s_add_u32 m0, s26, 1024
    s_nop 0
    global_load_lds_dwordx4 v9, s[22:23]
    s_add_u32 m0, s26, 2048
    s_nop 0
    global_load_lds_dwordx4 v10, s[22:23]
    s_add_u32 m0, s26, 3072
    s_nop 0
    global_load_lds_dwordx4 v11, s[22:23]
    s_add_u32 s22, s22, 221184
    s_addc_u32 s23, s23, 0
    s_add_u32 m0, s26, 16384
    s_nop 0
    global_load_lds_dwordx4 v8, s[22:23]
    s_add_u32 m0, s26, 17408
    s_nop 0
    global_load_lds_dwordx4 v9, s[22:23]
    s_add_u32 m0, s26, 18432
    s_nop 0
    global_load_lds_dwordx4 v10, s[22:23]
    s_add_u32 m0, s26, 19456
    s_nop 0
    global_load_lds_dwordx4 v11, s[22:23]
    s_add_u32 s22, s22, 221184
    s_addc_u32 s23, s23, 0
    s_add_u32 m0, s26, 32768
    s_nop 0
    global_load_lds_dwordx4 v8, s[22:23]
    s_add_u32 m0, s26, 33792
    s_nop 0
    global_load_lds_dwordx4 v9, s[22:23]
    s_add_u32 m0, s26, 34816
    s_nop 0
    global_load_lds_dwordx4 v10, s[22:23]
    s_add_u32 m0, s26, 35840
    s_nop 0
    global_load_lds_dwordx4 v11, s[22:23]
    s_add_u32 s22, s22, 221184
    s_addc_u32 s23, s23, 0
    s_waitcnt vmcnt(8)
    s_barrier
    s_add_u32 m0, s26, 49152
    s_nop 0
    global_load_lds_dwordx4 v8, s[22:23]
    s_add_u32 m0, s26, 50176
    s_nop 0
    global_load_lds_dwordx4 v9, s[22:23]
    s_add_u32 m0, s26, 51200
    s_nop 0
    global_load_lds_dwordx4 v10, s[22:23]
    s_add_u32 m0, s26, 52224
    s_nop 0
    global_load_lds_dwordx4 v11, s[22:23]
    s_add_u32 s22, s22, 221184
    s_addc_u32 s23, s23, 0
    ds_read_b64_tr_b16 a[0:1], v20 offset:0
    ds_read_b64_tr_b16 a[2:3], v20 offset:512
    ds_read_b64_tr_b16 a[4:5], v20 offset:2048
    ds_read_b64_tr_b16 a[6:7], v20 offset:2560
    ds_read_b64_tr_b16 a[8:9], v20 offset:4096
    ds_read_b64_tr_b16 a[10:11], v20 offset:4608
    ds_read_b64_tr_b16 a[12:13], v20 offset:6144
    ds_read_b64_tr_b16 a[14:15], v20 offset:6656
    s_waitcnt lgkmcnt(0)
    s_waitcnt vmcnt(8)
    s_barrier
    s_add_u32 m0, s26, 0
    s_nop 0
    global_load_lds_dwordx4 v8, s[22:23]
    s_add_u32 m0, s26, 1024
    s_nop 0
    global_load_lds_dwordx4 v9, s[22:23]
    s_add_u32 m0, s26, 2048
    s_nop 0
    global_load_lds_dwordx4 v10, s[22:23]
    s_add_u32 m0, s26, 3072
    s_nop 0
    global_load_lds_dwordx4 v11, s[22:23]
    s_add_u32 s22, s22, 221184
    s_addc_u32 s23, s23, 0
    ds_read_b64_tr_b16 a[16:17], v20 offset:16384
    ds_read_b64_tr_b16 a[18:19], v20 offset:16896
    ds_read_b64_tr_b16 a[20:21], v20 offset:18432
    ds_read_b64_tr_b16 a[22:23], v20 offset:18944
    ds_read_b64_tr_b16 a[24:25], v20 offset:20480
    ds_read_b64_tr_b16 a[26:27], v20 offset:20992
    ds_read_b64_tr_b16 a[28:29], v20 offset:22528
    ds_read_b64_tr_b16 a[30:31], v20 offset:23040
    s_waitcnt lgkmcnt(0)
    s_waitcnt vmcnt(8)
    s_barrier
    s_add_u32 m0, s26, 16384
    s_nop 0
    global_load_lds_dwordx4 v8, s[22:23]
    s_add_u32 m0, s26, 17408
    s_nop 0
    global_load_lds_dwordx4 v9, s[22:23]
    s_add_u32 m0, s26, 18432
    s_nop 0
    global_load_lds_dwordx4 v10, s[22:23]
    s_add_u32 m0, s26, 19456
    s_nop 0
    global_load_lds_dwordx4 v11, s[22:23]
    s_add_u32 s22, s22, 221184
    s_addc_u32 s23, s23, 0
    ds_read_b64_tr_b16 a[32:33], v20 offset:32768
    ds_read_b64_tr_b16 a[34:35], v20 offset:33280
    ds_read_b64_tr_b16 a[36:37], v20 offset:34816
    ds_read_b64_tr_b16 a[38:39], v20 offset:35328
    ds_read_b64_tr_b16 a[40:41], v20 offset:36864
    ds_read_b64_tr_b16 a[42:43], v20 offset:37376
    ds_read_b64_tr_b16 a[44:45], v20 offset:38912
    ds_read_b64_tr_b16 a[46:47], v20 offset:39424
    s_waitcnt lgkmcnt(0)
    s_waitcnt vmcnt(8)
    s_barrier
    s_add_u32 m0, s26, 32768
    s_nop 0
    global_load_lds_dwordx4 v8, s[22:23]
    s_add_u32 m0, s26, 33792
    s_nop 0
    global_load_lds_dwordx4 v9, s[22:23]
    s_add_u32 m0, s26, 34816
    s_nop 0
    global_load_lds_dwordx4 v10, s[22:23]
    s_add_u32 m0, s26, 35840
    s_nop 0
    global_load_lds_dwordx4 v11, s[22:23]
    s_add_u32 s22, s22, 221184
    s_addc_u32 s23, s23, 0
    ds_read_b64_tr_b16 a[48:49], v20 offset:49152
    ds_read_b64_tr_b16 a[50:51], v20 offset:49664
    ds_read_b64_tr_b16 a[52:53], v20 offset:51200
    ds_read_b64_tr_b16 a[54:55], v20 offset:51712
    ds_read_b64_tr_b16 a[56:57], v20 offset:53248
    ds_read_b64_tr_b16 a[58:59], v20 offset:53760
    ds_read_b64_tr_b16 a[60:61], v20 offset:55296
    ds_read_b64_tr_b16 a[62:63], v20 offset:55808
    s_waitcnt lgkmcnt(0)
    s_waitcnt vmcnt(8)
    s_barrier
    s_add_u32 m0, s26, 49152
    s_nop 0
    global_load_lds_dwordx4 v8, s[22:23]
    s_add_u32 m0, s26, 50176
    s_nop 0
    global_load_lds_dwordx4 v9, s[22:23]
    s_add_u32 m0, s26, 51200
    s_nop 0
    global_load_lds_dwordx4 v10, s[22:23]
    s_add_u32 m0, s26, 52224
    s_nop 0
    global_load_lds_dwordx4 v11, s[22:23]
    s_add_u32 s22, s22, 221184
    s_addc_u32 s23, s23, 0
    ds_read_b64_tr_b16 a[64:65], v20 offset:0
    ds_read_b64_tr_b16 a[66:67], v20 offset:512
    ds_read_b64_tr_b16 a[68:69], v20 offset:2048
    ds_read_b64_tr_b16 a[70:71], v20 offset:2560
    ds_read_b64_tr_b16 a[72:73], v20 offset:4096
    ds_read_b64_tr_b16 a[74:75], v20 offset:4608
    ds_read_b64_tr_b16 a[76:77], v20 offset:6144
    ds_read_b64_tr_b16 a[78:79], v20 offset:6656
    s_waitcnt lgkmcnt(0)
    s_waitcnt vmcnt(8)
    s_barrier
    s_add_u32 m0, s26, 0
    s_nop 0
    global_load_lds_dwordx4 v8, s[22:23]
    s_add_u32 m0, s26, 1024
    s_nop 0
    global_load_lds_dwordx4 v9, s[22:23]
    s_add_u32 m0, s26, 2048
    s_nop 0
    global_load_lds_dwordx4 v10, s[22:23]
    s_add_u32 m0, s26, 3072
    s_nop 0
    global_load_lds_dwordx4 v11, s[22:23]
    s_add_u32 s22, s22, 221184
    s_addc_u32 s23, s23, 0
    ds_read_b64_tr_b16 a[80:81], v20 offset:16384
    ds_read_b64_tr_b16 a[82:83], v20 offset:16896
    ds_read_b64_tr_b16 a[84:85], v20 offset:18432
    ds_read_b64_tr_b16 a[86:87], v20 offset:18944
    ds_read_b64_tr_b16 a[88:89], v20 offset:20480
    ds_read_b64_tr_b16 a[90:91], v20 offset:20992
    ds_read_b64_tr_b16 a[92:93], v20 offset:22528
    ds_read_b64_tr_b16 a[94:95], v20 offset:23040
    s_waitcnt lgkmcnt(0)
    s_waitcnt vmcnt(8)
    s_barrier
    s_add_u32 m0, s26, 16384
    s_nop 0
    global_load_lds_dwordx4 v8, s[22:23]
    s_add_u32 m0, s26, 17408
    s_nop 0
    global_load_lds_dwordx4 v9, s[22:23]
    s_add_u32 m0, s26, 18432
    s_nop 0
    global_load_lds_dwordx4 v10, s[22:23]
    s_add_u32 m0, s26, 19456
    s_nop 0
    global_load_lds_dwordx4 v11, s[22:23]
    s_add_u32 s22, s22, 221184
    s_addc_u32 s23, s23, 0
    ds_read_b64_tr_b16 a[96:97], v20 offset:32768
    ds_read_b64_tr_b16 a[98:99], v20 offset:33280
    ds_read_b64_tr_b16 a[100:101], v20 offset:34816
    ds_read_b64_tr_b16 a[102:103], v20 offset:35328
    ds_read_b64_tr_b16 a[104:105], v20 offset:36864
    ds_read_b64_tr_b16 a[106:107], v20 offset:37376
    ds_read_b64_tr_b16 a[108:109], v20 offset:38912
    ds_read_b64_tr_b16 a[110:111], v20 offset:39424
    s_waitcnt lgkmcnt(0)
    s_waitcnt vmcnt(8)
    s_barrier
    ds_read_b64_tr_b16 a[112:113], v20 offset:49152
    ds_read_b64_tr_b16 a[114:115], v20 offset:49664
    ds_read_b64_tr_b16 a[116:117], v20 offset:51200
    ds_read_b64_tr_b16 a[118:119], v20 offset:51712
    ds_read_b64_tr_b16 a[120:121], v20 offset:53248
    ds_read_b64_tr_b16 a[122:123], v20 offset:53760
    ds_read_b64_tr_b16 a[124:125], v20 offset:55296
    ds_read_b64_tr_b16 a[126:127], v20 offset:55808
    s_waitcnt lgkmcnt(0)
    s_waitcnt vmcnt(4)
    s_barrier
    ds_read_b64_tr_b16 a[128:129], v20 offset:0
    ds_read_b64_tr_b16 a[130:131], v20 offset:512
    ds_read_b64_tr_b16 a[132:133], v20 offset:2048
    ds_read_b64_tr_b16 a[134:135], v20 offset:2560
    ds_read_b64_tr_b16 a[136:137], v20 offset:4096
    ds_read_b64_tr_b16 a[138:139], v20 offset:4608
    ds_read_b64_tr_b16 a[140:141], v20 offset:6144
    ds_read_b64_tr_b16 a[142:143], v20 offset:6656
    s_waitcnt lgkmcnt(0)
    s_waitcnt vmcnt(0)
    s_barrier
    ds_read_b64_tr_b16 a[144:145], v20 offset:16384
    ds_read_b64_tr_b16 a[146:147], v20 offset:16896
    ds_read_b64_tr_b16 a[148:149], v20 offset:18432
    ds_read_b64_tr_b16 a[150:151], v20 offset:18944
    ds_read_b64_tr_b16 a[152:153], v20 offset:20480
    ds_read_b64_tr_b16 a[154:155], v20 offset:20992
    ds_read_b64_tr_b16 a[156:157], v20 offset:22528
    ds_read_b64_tr_b16 a[158:159], v20 offset:23040
    s_waitcnt lgkmcnt(0)
    s_barrier
    s_mov_b32 s20, 0x3333334
    s_mov_b32 s21, 1280
    s_lshl_b32 s24, s10, 6
    s_add_u32 s24, s24, 0
    v_add_u32 v12, s24, v2
    v_mul_hi_u32 v13, v12, s20
    v_mul_u32_u24 v14, 80, v13
    v_sub_u32 v14, v12, v14
    v_and_b32 v15, 7, v13
    v_xor_b32 v14, v14, v15
    v_lshlrev_b32 v14, 4, v14
    v_mul_lo_u32 v13, v13, s21
    v_add_u32 v40, v13, v14
    s_lshl_b32 s24, s10, 6
    s_add_u32 s24, s24, 256
    v_add_u32 v12, s24, v2
    v_mul_hi_u32 v13, v12, s20
    v_mul_u32_u24 v14, 80, v13
    v_sub_u32 v14, v12, v14
    v_and_b32 v15, 7, v13
    v_xor_b32 v14, v14, v15
    v_lshlrev_b32 v14, 4, v14
    v_mul_lo_u32 v13, v13, s21
    v_add_u32 v41, v13, v14
    s_lshl_b32 s24, s10, 6
    s_add_u32 s24, s24, 512
    v_add_u32 v12, s24, v2
    v_mul_hi_u32 v13, v12, s20
    v_mul_u32_u24 v14, 80, v13
    v_sub_u32 v14, v12, v14
    v_and_b32 v15, 7, v13
    v_xor_b32 v14, v14, v15
    v_lshlrev_b32 v14, 4, v14
    v_mul_lo_u32 v13, v13, s21
    v_add_u32 v42, v13, v14
    s_lshl_b32 s24, s10, 6
    s_add_u32 s24, s24, 768
    v_add_u32 v12, s24, v2
    v_mul_hi_u32 v13, v12, s20
    v_mul_u32_u24 v14, 80, v13
    v_sub_u32 v14, v12, v14
    v_and_b32 v15, 7, v13
    v_xor_b32 v14, v14, v15
    v_lshlrev_b32 v14, 4, v14
    v_mul_lo_u32 v13, v13, s21
    v_add_u32 v43, v13, v14
    s_lshl_b32 s24, s10, 6
    s_add_u32 s24, s24, 1024
    v_add_u32 v12, s24, v2
    v_mul_hi_u32 v13, v12, s20
    v_mul_u32_u24 v14, 80, v13
    v_sub_u32 v14, v12, v14
    v_and_b32 v15, 7, v13
    v_xor_b32 v14, v14, v15
    v_lshlrev_b32 v14, 4, v14
    v_mul_lo_u32 v13, v13, s21
    v_add_u32 v44, v13, v14
    s_lshl_b32 s24, s10, 6
    s_add_u32 s24, s24, 1280
    v_add_u32 v12, s24, v2
    v_mul_hi_u32 v13, v12, s20
    v_mul_u32_u24 v14, 80, v13
    v_sub_u32 v14, v12, v14
    v_and_b32 v15, 7, v13
    v_xor_b32 v14, v14, v15
    v_lshlrev_b32 v14, 4, v14
    v_mul_lo_u32 v13, v13, s21
    v_add_u32 v45, v13, v14
    s_lshl_b32 s24, s10, 6
    s_add_u32 s24, s24, 1536
    v_add_u32 v12, s24, v2
    v_mul_hi_u32 v13, v12, s20
    v_mul_u32_u24 v14, 80, v13
    v_sub_u32 v14, v12, v14
    v_and_b32 v15, 7, v13
    v_xor_b32 v14, v14, v15
    v_lshlrev_b32 v14, 4, v14
    v_mul_lo_u32 v13, v13, s21
    v_add_u32 v46, v13, v14
    s_lshl_b32 s24, s10, 6
    s_add_u32 s24, s24, 1792
    v_add_u32 v12, s24, v2
    v_mul_hi_u32 v13, v12, s20
    v_mul_u32_u24 v14, 80, v13
    v_sub_u32 v14, v12, v14
    v_and_b32 v15, 7, v13
    v_xor_b32 v14, v14, v15
    v_lshlrev_b32 v14, 4, v14
    v_mul_lo_u32 v13, v13, s21
    v_add_u32 v47, v13, v14
    s_lshl_b32 s24, s10, 6
    s_add_u32 s24, s24, 2048
    v_add_u32 v12, s24, v2
    v_mul_hi_u32 v13, v12, s20
    v_mul_u32_u24 v14, 80, v13
    v_sub_u32 v14, v12, v14
    v_and_b32 v15, 7, v13
    v_xor_b32 v14, v14, v15
    v_lshlrev_b32 v14, 4, v14
    v_mul_lo_u32 v13, v13, s21
    v_add_u32 v48, v13, v14
    s_lshl_b32 s24, s10, 6
    s_add_u32 s24, s24, 2304
    v_add_u32 v12, s24, v2
    v_mul_hi_u32 v13, v12, s20
    v_mul_u32_u24 v14, 80, v13
    v_sub_u32 v14, v12, v14
    v_and_b32 v15, 7, v13
    v_xor_b32 v14, v14, v15
    v_lshlrev_b32 v14, 4, v14
    v_mul_lo_u32 v13, v13, s21
    v_add_u32 v49, v13, v14
    v_and_b32 v12, 31, v2
    v_mul_u32_u24 v12, 1280, v12
    v_lshrrev_b32 v13, 5, v2
    v_and_b32 v14, 7, v2
    v_xor_b32 v13, v13, v14
    v_lshlrev_b32 v13, 4, v13
    v_add_u32 v52, v12, v13
    v_xor_b32 v53, 32, v52
    v_xor_b32 v54, 64, v52
    v_xor_b32 v55, 96, v52
    v_and_b32 v12, 31, v2
    v_mul_u32_u24 v12, 3456, v12
    v_lshrrev_b32 v13, 5, v2
    v_lshlrev_b32 v13, 4, v13
    s_lshl_b32 s20, s70, 7
    s_lshl_b32 s21, s10, 5
    s_add_u32 s20, s20, s21
    v_add3_u32 v56, v12, v13, s20
    s_mul_hi_u32 s34, s70, 0x1c71c71d
    s_mul_i32 s35, s34, 9
    s_sub_u32 s35, s70, s35
    s_mov_b32 s12, s71
Lgu_76:
    s_lshl_b32 s31, s12, 7
    s_add_u32 s31, s31, 0x7408008
    s_cmp_lg_u32 s10, 0
    s_cbranch_scc1 Ldw_77
    v_mov_b32 v20, s31
Lq_80:
    global_load_dword v21, v20, s[4:5] sc1
    s_waitcnt vmcnt(0)
    v_readfirstlane_b32 s62, v21
    s_nop 3
    s_cmp_ge_u32 s62, 4
    s_cbranch_scc1 Lqo_81
    s_sleep 2
    s_sub_u32 s63, s63, 1
    s_cbranch_scc0 Lq_80
    s_branch Ldf_78
Lqo_81:
    v_mov_b32 v21, 0
    s_branch Ldr_79
Ldf_78:
    v_mov_b32 v21, 1
Ldr_79:
    v_mov_b32 v20, 159760
    ds_write_b32 v20, v21
    s_waitcnt lgkmcnt(0)
Ldw_77:
    s_barrier
    v_mov_b32 v20, 159760
    ds_read_b32 v21, v20
    s_waitcnt lgkmcnt(0)
    v_readfirstlane_b32 s62, v21
    s_nop 3
    s_cmp_lg_u32 s62, 0
    s_cbranch_scc1 Lendf_3
    s_mul_i32 s16, s12, 40960
    s_add_u32 s50, s4, 0x5800000
    s_addc_u32 s51, s5, 0
    s_add_u32 s50, s50, s16
    s_addc_u32 s51, s51, 0
    s_lshl_b32 s24, s10, 10
    s_add_u32 m0, s24, 0
    s_nop 0
    global_load_lds_dwordx4 v40, s[50:51] sc1
    s_lshl_b32 s24, s10, 10
    s_add_u32 m0, s24, 4096
    s_nop 0
    global_load_lds_dwordx4 v41, s[50:51] sc1
    s_lshl_b32 s24, s10, 10
    s_add_u32 m0, s24, 8192
    s_nop 0
    global_load_lds_dwordx4 v42, s[50:51] sc1
    s_lshl_b32 s24, s10, 10
    s_add_u32 m0, s24, 12288
    s_nop 0
    global_load_lds_dwordx4 v43, s[50:51] sc1
    s_lshl_b32 s24, s10, 10
    s_add_u32 m0, s24, 16384
    s_nop 0
    global_load_lds_dwordx4 v44, s[50:51] sc1
    s_lshl_b32 s24, s10, 10
    s_add_u32 m0, s24, 20480
    s_nop 0
    global_load_lds_dwordx4 v45, s[50:51] sc1
    s_lshl_b32 s24, s10, 10
    s_add_u32 m0, s24, 24576
    s_nop 0
    global_load_lds_dwordx4 v46, s[50:51] sc1
    s_lshl_b32 s24, s10, 10
    s_add_u32 m0, s24, 28672
    s_nop 0
    global_load_lds_dwordx4 v47, s[50:51] sc1
    s_lshl_b32 s24, s10, 10
    s_add_u32 m0, s24, 32768
    s_nop 0
    global_load_lds_dwordx4 v48, s[50:51] sc1
    s_lshl_b32 s24, s10, 10
    s_add_u32 m0, s24, 36864
    s_nop 0
    global_load_lds_dwordx4 v49, s[50:51] sc1
    s_waitcnt vmcnt(0)
    s_barrier
    ds_read_b128 v[80:83], v52 offset:0
    ds_read_b128 v[84:87], v53 offset:0
    ds_read_b128 v[88:91], v54 offset:0
    ds_read_b128 v[92:95], v55 offset:0
    s_waitcnt lgkmcnt(3)
    v_mfma_f32_32x32x16_bf16 v[64:79], a[0:3], v[80:83], 0
    ds_read_b128 v[80:83], v52 offset:128
    s_waitcnt lgkmcnt(3)
    v_mfma_f32_32x32x16_bf16 v[64:79], a[4:7], v[84:87], v[64:79]
    ds_read_b128 v[84:87], v53 offset:128
    s_waitcnt lgkmcnt(3)
    v_mfma_f32_32x32x16_bf16 v[64:79], a[8:11], v[88:91], v[64:79]
    ds_read_b128 v[88:91], v54 offset:128
    s_waitcnt lgkmcnt(3)
    v_mfma_f32_32x32x16_bf16 v[64:79], a[12:15], v[92:95], v[64:79]
    ds_read_b128 v[92:95], v55 offset:128
    s_waitcnt lgkmcnt(3)
    v_mfma_f32_32x32x16_bf16 v[64:79], a[16:19], v[80:83], v[64:79]
    ds_read_b128 v[80:83], v52 offset:256
    s_waitcnt lgkmcnt(3)
    v_mfma_f32_32x32x16_bf16 v[64:79], a[20:23], v[84:87], v[64:79]
    ds_read_b128 v[84:87], v53 offset:256
    s_waitcnt lgkmcnt(3)
    v_mfma_f32_32x32x16_bf16 v[64:79], a[24:27], v[88:91], v[64:79]
    ds_read_b128 v[88:91], v54 offset:256
    s_waitcnt lgkmcnt(3)
    v_mfma_f32_32x32x16_bf16 v[64:79], a[28:31], v[92:95], v[64:79]
    ds_read_b128 v[92:95], v55 offset:256
    s_waitcnt lgkmcnt(3)
    v_mfma_f32_32x32x16_bf16 v[64:79], a[32:35], v[80:83], v[64:79]
    ds_read_b128 v[80:83], v52 offset:384
    s_waitcnt lgkmcnt(3)
    v_mfma_f32_32x32x16_bf16 v[64:79], a[36:39], v[84:87], v[64:79]
    ds_read_b128 v[84:87], v53 offset:384
    s_waitcnt lgkmcnt(3)
    v_mfma_f32_32x32x16_bf16 v[64:79], a[40:43], v[88:91], v[64:79]
    ds_read_b128 v[88:91], v54 offset:384
    s_waitcnt lgkmcnt(3)
    v_mfma_f32_32x32x16_bf16 v[64:79], a[44:47], v[92:95], v[64:79]
    ds_read_b128 v[92:95], v55 offset:384
    s_waitcnt lgkmcnt(3)
    v_mfma_f32_32x32x16_bf16 v[64:79], a[48:51], v[80:83], v[64:79]
    ds_read_b128 v[80:83], v52 offset:512
    s_waitcnt lgkmcnt(3)
    v_mfma_f32_32x32x16_bf16 v[64:79], a[52:55], v[84:87], v[64:79]
    ds_read_b128 v[84:87], v53 offset:512
    s_waitcnt lgkmcnt(3)
    v_mfma_f32_32x32x16_bf16 v[64:79], a[56:59], v[88:91], v[64:79]
    ds_read_b128 v[88:91], v54 offset:512
    s_waitcnt lgkmcnt(3)
    v_mfma_f32_32x32x16_bf16 v[64:79], a[60:63], v[92:95], v[64:79]
    ds_read_b128 v[92:95], v55 offset:512
    s_waitcnt lgkmcnt(3)
    v_mfma_f32_32x32x16_bf16 v[64:79], a[64:67], v[80:83], v[64:79]
    ds_read_b128 v[80:83], v52 offset:640
    s_waitcnt lgkmcnt(3)
    v_mfma_f32_32x32x16_bf16 v[64:79], a[68:71], v[84:87], v[64:79]
    ds_read_b128 v[84:87], v53 offset:640
    s_waitcnt lgkmcnt(3)
    v_mfma_f32_32x32x16_bf16 v[64:79], a[72:75], v[88:91], v[64:79]
    ds_read_b128 v[88:91], v54 offset:640
    s_waitcnt lgkmcnt(3)
    v_mfma_f32_32x32x16_bf16 v[64:79], a[76:79], v[92:95], v[64:79]
    ds_read_b128 v[92:95], v55 offset:640
    s_waitcnt lgkmcnt(3)
    v_mfma_f32_32x32x16_bf16 v[64:79], a[80:83], v[80:83], v[64:79]
    ds_read_b128 v[80:83], v52 offset:768
    s_waitcnt lgkmcnt(3)
    v_mfma_f32_32x32x16_bf16 v[64:79], a[84:87], v[84:87], v[64:79]
    ds_read_b128 v[84:87], v53 offset:768
    s_waitcnt lgkmcnt(3)
    v_mfma_f32_32x32x16_bf16 v[64:79], a[88:91], v[88:91], v[64:79]
    ds_read_b128 v[88:91], v54 offset:768
    s_waitcnt lgkmcnt(3)
    v_mfma_f32_32x32x16_bf16 v[64:79], a[92:95], v[92:95], v[64:79]
    ds_read_b128 v[92:95], v55 offset:768
    s_waitcnt lgkmcnt(3)
    v_mfma_f32_32x32x16_bf16 v[64:79], a[96:99], v[80:83], v[64:79]
    ds_read_b128 v[80:83], v52 offset:896
    s_waitcnt lgkmcnt(3)
    v_mfma_f32_32x32x16_bf16 v[64:79], a[100:103], v[84:87], v[64:79]
    ds_read_b128 v[84:87], v53 offset:896
    s_waitcnt lgkmcnt(3)
    v_mfma_f32_32x32x16_bf16 v[64:79], a[104:107], v[88:91], v[64:79]
    ds_read_b128 v[88:91], v54 offset:896
    s_waitcnt lgkmcnt(3)
    v_mfma_f32_32x32x16_bf16 v[64:79], a[108:111], v[92:95], v[64:79]
    ds_read_b128 v[92:95], v55 offset:896
    s_waitcnt lgkmcnt(3)
    v_mfma_f32_32x32x16_bf16 v[64:79], a[112:115], v[80:83], v[64:79]
    ds_read_b128 v[80:83], v52 offset:1024
    s_waitcnt lgkmcnt(3)
    v_mfma_f32_32x32x16_bf16 v[64:79], a[116:119], v[84:87], v[64:79]
    ds_read_b128 v[84:87], v53 offset:1024
    s_waitcnt lgkmcnt(3)
    v_mfma_f32_32x32x16_bf16 v[64:79], a[120:123], v[88:91], v[64:79]
    ds_read_b128 v[88:91], v54 offset:1024
    s_waitcnt lgkmcnt(3)
    v_mfma_f32_32x32x16_bf16 v[64:79], a[124:127], v[92:95], v[64:79]
    ds_read_b128 v[92:95], v55 offset:1024
    s_waitcnt lgkmcnt(3)
    v_mfma_f32_32x32x16_bf16 v[64:79], a[128:131], v[80:83], v[64:79]
    ds_read_b128 v[80:83], v52 offset:1152
    s_waitcnt lgkmcnt(3)
    v_mfma_f32_32x32x16_bf16 v[64:79], a[132:135], v[84:87], v[64:79]
    ds_read_b128 v[84:87], v53 offset:1152
    s_waitcnt lgkmcnt(3)
    v_mfma_f32_32x32x16_bf16 v[64:79], a[136:139], v[88:91], v[64:79]
    ds_read_b128 v[88:91], v54 offset:1152
    s_waitcnt lgkmcnt(3)
    v_mfma_f32_32x32x16_bf16 v[64:79], a[140:143], v[92:95], v[64:79]
    ds_read_b128 v[92:95], v55 offset:1152
    s_waitcnt lgkmcnt(3)
    v_mfma_f32_32x32x16_bf16 v[64:79], a[144:147], v[80:83], v[64:79]
    s_waitcnt lgkmcnt(2)
    v_mfma_f32_32x32x16_bf16 v[64:79], a[148:151], v[84:87], v[64:79]
    s_waitcnt lgkmcnt(1)
    v_mfma_f32_32x32x16_bf16 v[64:79], a[152:155], v[88:91], v[64:79]
    s_waitcnt lgkmcnt(0)
    v_mfma_f32_32x32x16_bf16 v[64:79], a[156:159], v[92:95], v[64:79]
    s_nop 15
    v_cvt_pk_bf16_f32 v8, v64, v65
    v_lshlrev_b32 v10, 16, v8
    v_and_b32 v11, 0xffff0000, v8
    v_cvt_pk_bf16_f32 v8, v72, v73
    v_lshlrev_b32 v14, 16, v8
    v_and_b32 v15, 0xffff0000, v8
    v_cvt_pk_bf16_f32 v8, v66, v67
    v_lshlrev_b32 v12, 16, v8
    v_and_b32 v13, 0xffff0000, v8
    v_cvt_pk_bf16_f32 v8, v74, v75
    v_lshlrev_b32 v16, 16, v8
    v_and_b32 v17, 0xffff0000, v8
    v_mul_f32 v20, 0xbfb8aa3b, v10
    v_mul_f32 v21, 0xbfb8aa3b, v11
    v_mul_f32 v22, 0xbfb8aa3b, v12
    v_mul_f32 v23, 0xbfb8aa3b, v13
    v_exp_f32 v20, v20
    v_exp_f32 v21, v21
    v_exp_f32 v22, v22
    v_exp_f32 v23, v23
    s_nop 0
    v_add_f32 v20, 1.0, v20
    v_add_f32 v21, 1.0, v21
    v_add_f32 v22, 1.0, v22
    v_add_f32 v23, 1.0, v23
    v_rcp_f32 v20, v20
    v_rcp_f32 v21, v21
    v_rcp_f32 v22, v22
    v_rcp_f32 v23, v23
    s_nop 0
    v_mul_f32 v10, v10, v20
    v_mul_f32 v11, v11, v21
    v_mul_f32 v12, v12, v22
    v_mul_f32 v13, v13, v23
    v_cvt_pk_bf16_f32 v8, v10, v11
    v_lshlrev_b32 v10, 16, v8
    v_and_b32 v11, 0xffff0000, v8
    v_cvt_pk_bf16_f32 v8, v12, v13
    v_lshlrev_b32 v12, 16, v8
    v_and_b32 v13, 0xffff0000, v8
    v_mul_f32 v10, v10, v14
    v_mul_f32 v11, v11, v15
    v_mul_f32 v12, v12, v16
    v_mul_f32 v13, v13, v17
    v_cvt_pk_bf16_f32 v24, v10, v11
    v_cvt_pk_bf16_f32 v25, v12, v13
    v_cvt_pk_bf16_f32 v8, v68, v69
    v_lshlrev_b32 v10, 16, v8
    v_and_b32 v11, 0xffff0000, v8
    v_cvt_pk_bf16_f32 v8, v76, v77
    v_lshlrev_b32 v14, 16, v8
    v_and_b32 v15, 0xffff0000, v8
    v_cvt_pk_bf16_f32 v8, v70, v71
    v_lshlrev_b32 v12, 16, v8
    v_and_b32 v13, 0xffff0000, v8
    v_cvt_pk_bf16_f32 v8, v78, v79
    v_lshlrev_b32 v16, 16, v8
    v_and_b32 v17, 0xffff0000, v8
    v_mul_f32 v20, 0xbfb8aa3b, v10
    v_mul_f32 v21, 0xbfb8aa3b, v11
    v_mul_f32 v22, 0xbfb8aa3b, v12
    v_mul_f32 v23, 0xbfb8aa3b, v13
    v_exp_f32 v20, v20
    v_exp_f32 v21, v21
    v_exp_f32 v22, v22
    v_exp_f32 v23, v23
    s_nop 0
    v_add_f32 v20, 1.0, v20
    v_add_f32 v21, 1.0, v21
    v_add_f32 v22, 1.0, v22
    v_add_f32 v23, 1.0, v23
    v_rcp_f32 v20, v20
    v_rcp_f32 v21, v21
    v_rcp_f32 v22, v22
    v_rcp_f32 v23, v23
    s_nop 0
    v_mul_f32 v10, v10, v20
    v_mul_f32 v11, v11, v21
    v_mul_f32 v12, v12, v22
    v_mul_f32 v13, v13, v23
    v_cvt_pk_bf16_f32 v8, v10, v11
    v_lshlrev_b32 v10, 16, v8
    v_and_b32 v11, 0xffff0000, v8
    v_cvt_pk_bf16_f32 v8, v12, v13
    v_lshlrev_b32 v12, 16, v8
    v_and_b32 v13, 0xffff0000, v8
    v_mul_f32 v10, v10, v14
    v_mul_f32 v11, v11, v15
    v_mul_f32 v12, v12, v16
    v_mul_f32 v13, v13, v17
    v_cvt_pk_bf16_f32 v26, v10, v11
    v_cvt_pk_bf16_f32 v27, v12, v13
    s_nop 1
    v_permlane32_swap_b32 v24, v26
    v_permlane32_swap_b32 v25, v27
    s_mul_i32 s16, s12, 110592
    s_add_u32 s54, s4, 0x5c00000
    s_addc_u32 s55, s5, 0
    s_add_u32 s54, s54, s16
    s_addc_u32 s55, s55, 0
    global_store_dwordx4 v56, v[24:27], s[54:55] sc1
    s_lshl_b32 s16, s34, 2
    s_add_u32 s31, s31, s16
    s_add_u32 s31, s31, 4
    s_waitcnt vmcnt(0)
    s_barrier
    s_cmp_lg_u32 s10, 0
    s_cbranch_scc1 Lsg_82
    s_mov_b64 exec, 1
    v_mov_b32 v20, s31
    v_mov_b32 v21, 1
    global_atomic_add v20, v21, s[4:5]
    s_mov_b64 exec, -1
Lsg_82:
    s_add_u32 s12, s12, 2
    s_cmp_lt_u32 s12, 64
    s_cbranch_scc1 Lgu_76
    s_branch Lroles_11
Lrdn_48:
    s_mul_hi_u32 s71, s64, 0x11111112
    s_mul_i32 s66, s71, 15
    s_sub_u32 s66, s64, s66
    s_mul_hi_u32 s70, s66, 0x33333334
    s_mul_i32 s72, s70, 5
    s_sub_u32 s72, s66, s72
    s_load_dwordx2 s[40:41], s[0:1], 80
    s_load_dwordx2 s[42:43], s[0:1], 88
    s_waitcnt lgkmcnt(0)
    s_mul_i32 s16, s70, 737280
    s_lshl_b32 s17, s72, 8
    s_add_u32 s16, s16, s17
    s_add_u32 s46, s40, s16
    s_addc_u32 s47, s41, 0
    s_add_u32 s48, s46, 128
    s_addc_u32 s49, s47, 0
    s_mov_b32 s74, s42
    s_mov_b32 s75, s43
    v_lshrrev_b32 v12, 3, v2
    v_and_b32 v13, 7, v2
    v_bfe_u32 v14, v12, 1, 1
    v_lshlrev_b32 v14, 2, v14
    v_xor_b32 v14, v13, v14
    v_lshlrev_b32 v14, 4, v14
    s_and_b32 s20, s10, 1
    s_lshl_b32 s20, s20, 5
    v_add_u32 v15, s20, v12
    s_mov_b32 s21, 1280
    v_mul_lo_u32 v15, v15, s21
    v_add_u32 v8, v15, v14
    v_add_u32 v9, 10240, v8
    v_add_u32 v10, 20480, v8
    v_add_u32 v11, 30720, v8
    s_cmp_ge_u32 s10, 2
    s_cselect_b32 s22, s48, s46
    s_cselect_b32 s23, s49, s47
    s_lshl_b32 s26, s10, 12
    v_bfe_u32 v12, v2, 4, 1
    v_lshrrev_b32 v13, 5, v2
    v_bfe_u32 v14, v2, 2, 2
    v_and_b32 v15, 3, v2
    v_lshlrev_b32 v20, 3, v13
    v_add_u32 v20, v20, v14
    v_lshlrev_b32 v20, 7, v20
    v_lshrrev_b32 v22, 1, v15
    v_lshlrev_b32 v21, 1, v12
    v_add_u32 v21, v21, v22
    s_and_b32 s20, s10, 1
    s_lshl_b32 s20, s20, 2
    v_add_u32 v21, s20, v21
    s_lshr_b32 s20, s10, 1
    s_lshl_b32 s20, s20, 13
    v_add_u32 v20, s20, v20
    v_lshrrev_b32 v22, 1, v14
    v_lshlrev_b32 v22, 2, v22
    v_xor_b32 v21, v21, v22
    v_lshlrev_b32 v21, 4, v21
    v_and_b32 v22, 1, v15
    v_lshlrev_b32 v22, 3, v22
    v_add3_u32 v20, v20, v21, v22
    s_add_u32 m0, s26, 0
    s_nop 0
    global_load_lds_dwordx4 v8, s[22:23]
    s_add_u32 m0, s26, 1024
    s_nop 0
    global_load_lds_dwordx4 v9, s[22:23]
    s_add_u32 m0, s26, 2048
    s_nop 0
    global_load_lds_dwordx4 v10, s[22:23]
    s_add_u32 m0, s26, 3072
    s_nop 0
    global_load_lds_dwordx4 v11, s[22:23]
    s_add_u32 s22, s22, 81920
    s_addc_u32 s23, s23, 0
    s_add_u32 m0, s26, 16384
    s_nop 0
    global_load_lds_dwordx4 v8, s[22:23]
    s_add_u32 m0, s26, 17408
    s_nop 0
    global_load_lds_dwordx4 v9, s[22:23]
    s_add_u32 m0, s26, 18432
    s_nop 0
    global_load_lds_dwordx4 v10, s[22:23]
    s_add_u32 m0, s26, 19456
    s_nop 0
    global_load_lds_dwordx4 v11, s[22:23]
    s_add_u32 s22, s22, 81920
    s_addc_u32 s23, s23, 0
    s_add_u32 m0, s26, 32768
    s_nop 0
    global_load_lds_dwordx4 v8, s[22:23]
    s_add_u32 m0, s26, 33792
    s_nop 0
    global_load_lds_dwordx4 v9, s[22:23]
    s_add_u32 m0, s26, 34816
    s_nop 0
    global_load_lds_dwordx4 v10, s[22:23]
    s_add_u32 m0, s26, 35840
    s_nop 0
    global_load_lds_dwordx4 v11, s[22:23]
    s_add_u32 s22, s22, 81920
    s_addc_u32 s23, s23, 0
    s_waitcnt vmcnt(8)
    s_barrier
    s_add_u32 m0, s26, 49152
    s_nop 0
    global_load_lds_dwordx4 v8, s[22:23]
    s_add_u32 m0, s26, 50176
    s_nop 0
    global_load_lds_dwordx4 v9, s[22:23]
    s_add_u32 m0, s26, 51200
    s_nop 0
    global_load_lds_dwordx4 v10, s[22:23]
    s_add_u32 m0, s26, 52224
    s_nop 0
    global_load_lds_dwordx4 v11, s[22:23]
    s_add_u32 s22, s22, 81920
    s_addc_u32 s23, s23, 0
    ds_read_b64_tr_b16 a[0:1], v20 offset:0
    ds_read_b64_tr_b16 a[2:3], v20 offset:512
    ds_read_b64_tr_b16 a[4:5], v20 offset:2048
    ds_read_b64_tr_b16 a[6:7], v20 offset:2560
    ds_read_b64_tr_b16 a[8:9], v20 offset:4096
    ds_read_b64_tr_b16 a[10:11], v20 offset:4608
    ds_read_b64_tr_b16 a[12:13], v20 offset:6144
    ds_read_b64_tr_b16 a[14:15], v20 offset:6656
    s_waitcnt lgkmcnt(0)
    s_waitcnt vmcnt(8)
    s_barrier
    s_add_u32 m0, s26, 0
    s_nop 0
    global_load_lds_dwordx4 v8, s[22:23]
    s_add_u32 m0, s26, 1024
    s_nop 0
    global_load_lds_dwordx4 v9, s[22:23]
    s_add_u32 m0, s26, 2048
    s_nop 0
    global_load_lds_dwordx4 v10, s[22:23]
    s_add_u32 m0, s26, 3072
    s_nop 0
    global_load_lds_dwordx4 v11, s[22:23]
    s_add_u32 s22, s22, 81920
    s_addc_u32 s23, s23, 0
    ds_read_b64_tr_b16 a[16:17], v20 offset:16384
    ds_read_b64_tr_b16 a[18:19], v20 offset:16896
    ds_read_b64_tr_b16 a[20:21], v20 offset:18432
    ds_read_b64_tr_b16 a[22:23], v20 offset:18944
    ds_read_b64_tr_b16 a[24:25], v20 offset:20480
    ds_read_b64_tr_b16 a[26:27], v20 offset:20992
    ds_read_b64_tr_b16 a[28:29], v20 offset:22528
    ds_read_b64_tr_b16 a[30:31], v20 offset:23040
    s_waitcnt lgkmcnt(0)
    s_waitcnt vmcnt(8)
    s_barrier
    s_add_u32 m0, s26, 16384
    s_nop 0
    global_load_lds_dwordx4 v8, s[22:23]
    s_add_u32 m0, s26, 17408
    s_nop 0
    global_load_lds_dwordx4 v9, s[22:23]
    s_add_u32 m0, s26, 18432
    s_nop 0
    global_load_lds_dwordx4 v10, s[22:23]
    s_add_u32 m0, s26, 19456
    s_nop 0
    global_load_lds_dwordx4 v11, s[22:23]
    s_add_u32 s22, s22, 81920
    s_addc_u32 s23, s23, 0
    ds_read_b64_tr_b16 a[32:33], v20 offset:32768
    ds_read_b64_tr_b16 a[34:35], v20 offset:33280
    ds_read_b64_tr_b16 a[36:37], v20 offset:34816
    ds_read_b64_tr_b16 a[38:39], v20 offset:35328
    ds_read_b64_tr_b16 a[40:41], v20 offset:36864
    ds_read_b64_tr_b16 a[42:43], v20 offset:37376
    ds_read_b64_tr_b16 a[44:45], v20 offset:38912
    ds_read_b64_tr_b16 a[46:47], v20 offset:39424
    s_waitcnt lgkmcnt(0)
    s_waitcnt vmcnt(8)
    s_barrier
    s_add_u32 m0, s26, 32768
    s_nop 0
    global_load_lds_dwordx4 v8, s[22:23]
    s_add_u32 m0, s26, 33792
    s_nop 0
    global_load_lds_dwordx4 v9, s[22:23]
    s_add_u32 m0, s26, 34816
    s_nop 0
    global_load_lds_dwordx4 v10, s[22:23]
    s_add_u32 m0, s26, 35840
    s_nop 0
    global_load_lds_dwordx4 v11, s[22:23]
    s_add_u32 s22, s22, 81920
    s_addc_u32 s23, s23, 0
    ds_read_b64_tr_b16 a[48:49], v20 offset:49152
    ds_read_b64_tr_b16 a[50:51], v20 offset:49664
    ds_read_b64_tr_b16 a[52:53], v20 offset:51200
    ds_read_b64_tr_b16 a[54:55], v20 offset:51712
    ds_read_b64_tr_b16 a[56:57], v20 offset:53248
    ds_read_b64_tr_b16 a[58:59], v20 offset:53760
    ds_read_b64_tr_b16 a[60:61], v20 offset:55296
    ds_read_b64_tr_b16 a[62:63], v20 offset:55808
    s_waitcnt lgkmcnt(0)
    s_waitcnt vmcnt(8)
    s_barrier
    s_add_u32 m0, s26, 49152
    s_nop 0
    global_load_lds_dwordx4 v8, s[22:23]
    s_add_u32 m0, s26, 50176
    s_nop 0
    global_load_lds_dwordx4 v9, s[22:23]
    s_add_u32 m0, s26, 51200
    s_nop 0
    global_load_lds_dwordx4 v10, s[22:23]
    s_add_u32 m0, s26, 52224
    s_nop 0
    global_load_lds_dwordx4 v11, s[22:23]
    s_add_u32 s22, s22, 81920
    s_addc_u32 s23, s23, 0
    ds_read_b64_tr_b16 a[64:65], v20 offset:0
    ds_read_b64_tr_b16 a[66:67], v20 offset:512
    ds_read_b64_tr_b16 a[68:69], v20 offset:2048
    ds_read_b64_tr_b16 a[70:71], v20 offset:2560
    ds_read_b64_tr_b16 a[72:73], v20 offset:4096
    ds_read_b64_tr_b16 a[74:75], v20 offset:4608
    ds_read_b64_tr_b16 a[76:77], v20 offset:6144
    ds_read_b64_tr_b16 a[78:79], v20 offset:6656
    s_waitcnt lgkmcnt(0)
    s_waitcnt vmcnt(8)
    s_barrier
    s_add_u32 m0, s26, 0
    s_nop 0
    global_load_lds_dwordx4 v8, s[22:23]
    s_add_u32 m0, s26, 1024
    s_nop 0
    global_load_lds_dwordx4 v9, s[22:23]
    s_add_u32 m0, s26, 2048
    s_nop 0
    global_load_lds_dwordx4 v10, s[22:23]
    s_add_u32 m0, s26, 3072
    s_nop 0
    global_load_lds_dwordx4 v11, s[22:23]
    s_add_u32 s22, s22, 81920
    s_addc_u32 s23, s23, 0
    ds_read_b64_tr_b16 a[80:81], v20 offset:16384
    ds_read_b64_tr_b16 a[82:83], v20 offset:16896
    ds_read_b64_tr_b16 a[84:85], v20 offset:18432
    ds_read_b64_tr_b16 a[86:87], v20 offset:18944
    ds_read_b64_tr_b16 a[88:89], v20 offset:20480
    ds_read_b64_tr_b16 a[90:91], v20 offset:20992
    ds_read_b64_tr_b16 a[92:93], v20 offset:22528
    ds_read_b64_tr_b16 a[94:95], v20 offset:23040
    s_waitcnt lgkmcnt(0)
    s_waitcnt vmcnt(8)
    s_barrier
    ds_read_b64_tr_b16 a[96:97], v20 offset:32768
    ds_read_b64_tr_b16 a[98:99], v20 offset:33280
    ds_read_b64_tr_b16 a[100:101], v20 offset:34816
    ds_read_b64_tr_b16 a[102:103], v20 offset:35328
    ds_read_b64_tr_b16 a[104:105], v20 offset:36864
    ds_read_b64_tr_b16 a[106:107], v20 offset:37376
    ds_read_b64_tr_b16 a[108:109], v20 offset:38912
    ds_read_b64_tr_b16 a[110:111], v20 offset:39424
    s_waitcnt lgkmcnt(0)
    s_waitcnt vmcnt(4)
    s_barrier
    ds_read_b64_tr_b16 a[112:113], v20 offset:49152
    ds_read_b64_tr_b16 a[114:115], v20 offset:49664
    ds_read_b64_tr_b16 a[116:117], v20 offset:51200
    ds_read_b64_tr_b16 a[118:119], v20 offset:51712
    ds_read_b64_tr_b16 a[120:121], v20 offset:53248
    ds_read_b64_tr_b16 a[122:123], v20 offset:53760
    ds_read_b64_tr_b16 a[124:125], v20 offset:55296
    ds_read_b64_tr_b16 a[126:127], v20 offset:55808
    s_waitcnt lgkmcnt(0)
    s_waitcnt vmcnt(0)
    s_barrier
    ds_read_b64_tr_b16 a[128:129], v20 offset:0
    ds_read_b64_tr_b16 a[130:131], v20 offset:512
    ds_read_b64_tr_b16 a[132:133], v20 offset:2048
    ds_read_b64_tr_b16 a[134:135], v20 offset:2560
    ds_read_b64_tr_b16 a[136:137], v20 offset:4096
    ds_read_b64_tr_b16 a[138:139], v20 offset:4608
    ds_read_b64_tr_b16 a[140:141], v20 offset:6144
    ds_read_b64_tr_b16 a[142:143], v20 offset:6656
    s_waitcnt lgkmcnt(0)
    s_barrier
    s_mov_b32 s20, 0x38e38e4
    s_mov_b32 s21, 3456
    s_lshl_b32 s24, s10, 6
    s_add_u32 s24, s24, 0
    v_add_u32 v12, s24, v2
    v_mul_hi_u32 v13, v12, s20
    v_mul_u32_u24 v14, 72, v13
    v_sub_u32 v14, v12, v14
    v_and_b32 v15, 7, v13
    v_xor_b32 v14, v14, v15
    v_lshlrev_b32 v14, 4, v14
    v_mul_lo_u32 v13, v13, s21
    v_add_u32 v40, v13, v14
    s_lshl_b32 s24, s10, 6
    s_add_u32 s24, s24, 256
    v_add_u32 v12, s24, v2
    v_mul_hi_u32 v13, v12, s20
    v_mul_u32_u24 v14, 72, v13
    v_sub_u32 v14, v12, v14
    v_and_b32 v15, 7, v13
    v_xor_b32 v14, v14, v15
    v_lshlrev_b32 v14, 4, v14
    v_mul_lo_u32 v13, v13, s21
    v_add_u32 v41, v13, v14
    s_lshl_b32 s24, s10, 6
    s_add_u32 s24, s24, 512
    v_add_u32 v12, s24, v2
    v_mul_hi_u32 v13, v12, s20
    v_mul_u32_u24 v14, 72, v13
    v_sub_u32 v14, v12, v14
    v_and_b32 v15, 7, v13
    v_xor_b32 v14, v14, v15
    v_lshlrev_b32 v14, 4, v14
    v_mul_lo_u32 v13, v13, s21
    v_add_u32 v42, v13, v14
    s_lshl_b32 s24, s10, 6
    s_add_u32 s24, s24, 768
    v_add_u32 v12, s24, v2
    v_mul_hi_u32 v13, v12, s20
    v_mul_u32_u24 v14, 72, v13
    v_sub_u32 v14, v12, v14
    v_and_b32 v15, 7, v13
    v_xor_b32 v14, v14, v15
    v_lshlrev_b32 v14, 4, v14
    v_mul_lo_u32 v13, v13, s21
    v_add_u32 v43, v13, v14
    s_lshl_b32 s24, s10, 6
    s_add_u32 s24, s24, 1024
    v_add_u32 v12, s24, v2
    v_mul_hi_u32 v13, v12, s20
    v_mul_u32_u24 v14, 72, v13
    v_sub_u32 v14, v12, v14
    v_and_b32 v15, 7, v13
    v_xor_b32 v14, v14, v15
    v_lshlrev_b32 v14, 4, v14
    v_mul_lo_u32 v13, v13, s21
    v_add_u32 v44, v13, v14
    s_lshl_b32 s24, s10, 6
    s_add_u32 s24, s24, 1280
    v_add_u32 v12, s24, v2
    v_mul_hi_u32 v13, v12, s20
    v_mul_u32_u24 v14, 72, v13
    v_sub_u32 v14, v12, v14
    v_and_b32 v15, 7, v13
    v_xor_b32 v14, v14, v15
    v_lshlrev_b32 v14, 4, v14
    v_mul_lo_u32 v13, v13, s21
    v_add_u32 v45, v13, v14
    s_lshl_b32 s24, s10, 6
    s_add_u32 s24, s24, 1536
    v_add_u32 v12, s24, v2
    v_mul_hi_u32 v13, v12, s20
    v_mul_u32_u24 v14, 72, v13
    v_sub_u32 v14, v12, v14
    v_and_b32 v15, 7, v13
    v_xor_b32 v14, v14, v15
    v_lshlrev_b32 v14, 4, v14
    v_mul_lo_u32 v13, v13, s21
    v_add_u32 v46, v13, v14
    s_lshl_b32 s24, s10, 6
    s_add_u32 s24, s24, 1792
    v_add_u32 v12, s24, v2
    v_mul_hi_u32 v13, v12, s20
    v_mul_u32_u24 v14, 72, v13
    v_sub_u32 v14, v12, v14
    v_and_b32 v15, 7, v13
    v_xor_b32 v14, v14, v15
    v_lshlrev_b32 v14, 4, v14
    v_mul_lo_u32 v13, v13, s21
    v_add_u32 v47, v13, v14
    s_lshl_b32 s24, s10, 6
    s_add_u32 s24, s24, 2048
    v_add_u32 v12, s24, v2
    v_mul_hi_u32 v13, v12, s20
    v_mul_u32_u24 v14, 72, v13
    v_sub_u32 v14, v12, v14
    v_and_b32 v15, 7, v13
    v_xor_b32 v14, v14, v15
    v_lshlrev_b32 v14, 4, v14
    v_mul_lo_u32 v13, v13, s21
    v_add_u32 v48, v13, v14
    v_and_b32 v12, 31, v2
    v_mul_u32_u24 v12, 1152, v12
    v_lshrrev_b32 v13, 5, v2
    v_and_b32 v14, 7, v2
    v_xor_b32 v13, v13, v14
    v_lshlrev_b32 v13, 4, v13
    v_add_u32 v52, v12, v13
    v_xor_b32 v53, 32, v52
    v_xor_b32 v54, 64, v52
    v_xor_b32 v55, 96, v52
    v_and_b32 v12, 31, v2
    v_mul_u32_u24 v12, 1280, v12
    v_lshrrev_b32 v13, 5, v2
    v_lshlrev_b32 v13, 4, v13
    s_lshl_b32 s20, s72, 8
    s_lshl_b32 s21, s10, 6
    s_add_u32 s20, s20, s21
    v_add3_u32 v56, v12, v13, s20
    v_lshlrev_b32 v57, 4, v2
    s_lshl_b32 s20, s10, 12
    v_add_u32 v57, s20, v57
    s_mov_b32 s12, s71
Ldn_83:
    s_lshl_b32 s31, s12, 7
    s_lshl_b32 s16, s70, 2
    s_add_u32 s31, s31, s16
    s_add_u32 s31, s31, 0x740800c
    s_cmp_lg_u32 s10, 0
    s_cbranch_scc1 Ldw_84
    v_mov_b32 v20, s31
Lq_87:
    global_load_dword v21, v20, s[4:5] sc1
    s_waitcnt vmcnt(0)
    v_readfirstlane_b32 s62, v21
    s_nop 3
    s_cmp_ge_u32 s62, 9
    s_cbranch_scc1 Lqo_88
    s_sleep 2
    s_sub_u32 s63, s63, 1
    s_cbranch_scc0 Lq_87
    s_branch Ldf_85
Lqo_88:
    v_mov_b32 v21, 0
    s_branch Ldr_86
Ldf_85:
    v_mov_b32 v21, 1
Ldr_86:
    v_mov_b32 v20, 159760
    ds_write_b32 v20, v21
    s_waitcnt lgkmcnt(0)
Ldw_84:
    s_barrier
    v_mov_b32 v20, 159760
    ds_read_b32 v21, v20
    s_waitcnt lgkmcnt(0)
    v_readfirstlane_b32 s62, v21
    s_nop 3
    s_cmp_lg_u32 s62, 0
    s_cbranch_scc1 Lendf_3
    s_mul_i32 s16, s12, 110592
    s_mul_i32 s17, s70, 1152
    s_add_u32 s16, s16, s17
    s_add_u32 s50, s4, 0x5c00000
    s_addc_u32 s51, s5, 0
    s_add_u32 s50, s50, s16
    s_addc_u32 s51, s51, 0
    s_lshl_b32 s24, s10, 10
    s_add_u32 m0, s24, 0
    s_nop 0
    global_load_lds_dwordx4 v40, s[50:51] sc1
    s_lshl_b32 s24, s10, 10
    s_add_u32 m0, s24, 4096
    s_nop 0
    global_load_lds_dwordx4 v41, s[50:51] sc1
    s_lshl_b32 s24, s10, 10
    s_add_u32 m0, s24, 8192
    s_nop 0
    global_load_lds_dwordx4 v42, s[50:51] sc1
    s_lshl_b32 s24, s10, 10
    s_add_u32 m0, s24, 12288
    s_nop 0
    global_load_lds_dwordx4 v43, s[50:51] sc1
    s_lshl_b32 s24, s10, 10
    s_add_u32 m0, s24, 16384
    s_nop 0
    global_load_lds_dwordx4 v44, s[50:51] sc1
    s_lshl_b32 s24, s10, 10
    s_add_u32 m0, s24, 20480
    s_nop 0
    global_load_lds_dwordx4 v45, s[50:51] sc1
    s_lshl_b32 s24, s10, 10
    s_add_u32 m0, s24, 24576
    s_nop 0
    global_load_lds_dwordx4 v46, s[50:51] sc1
    s_lshl_b32 s24, s10, 10
    s_add_u32 m0, s24, 28672
    s_nop 0
    global_load_lds_dwordx4 v47, s[50:51] sc1
    s_lshl_b32 s24, s10, 10
    s_add_u32 m0, s24, 32768
    s_nop 0
    global_load_lds_dwordx4 v48, s[50:51] sc1
    s_waitcnt vmcnt(0)
    s_barrier
    ds_read_b128 v[80:83], v52 offset:0
    ds_read_b128 v[84:87], v53 offset:0
    ds_read_b128 v[88:91], v54 offset:0
    ds_read_b128 v[92:95], v55 offset:0
    s_waitcnt lgkmcnt(3)
    v_mfma_f32_32x32x16_bf16 v[64:79], a[0:3], v[80:83], 0
    ds_read_b128 v[80:83], v52 offset:128
    s_waitcnt lgkmcnt(3)
    v_mfma_f32_32x32x16_bf16 v[64:79], a[4:7], v[84:87], v[64:79]
    ds_read_b128 v[84:87], v53 offset:128
    s_waitcnt lgkmcnt(3)
    v_mfma_f32_32x32x16_bf16 v[64:79], a[8:11], v[88:91], v[64:79]
    ds_read_b128 v[88:91], v54 offset:128
    s_waitcnt lgkmcnt(3)
    v_mfma_f32_32x32x16_bf16 v[64:79], a[12:15], v[92:95], v[64:79]
    ds_read_b128 v[92:95], v55 offset:128
    s_waitcnt lgkmcnt(3)
    v_mfma_f32_32x32x16_bf16 v[64:79], a[16:19], v[80:83], v[64:79]
    ds_read_b128 v[80:83], v52 offset:256
    s_waitcnt lgkmcnt(3)
    v_mfma_f32_32x32x16_bf16 v[64:79], a[20:23], v[84:87], v[64:79]
    ds_read_b128 v[84:87], v53 offset:256
    s_waitcnt lgkmcnt(3)
    v_mfma_f32_32x32x16_bf16 v[64:79], a[24:27], v[88:91], v[64:79]
    ds_read_b128 v[88:91], v54 offset:256
    s_waitcnt lgkmcnt(3)
    v_mfma_f32_32x32x16_bf16 v[64:79], a[28:31], v[92:95], v[64:79]
    ds_read_b128 v[92:95], v55 offset:256
    s_waitcnt lgkmcnt(3)
    v_mfma_f32_32x32x16_bf16 v[64:79], a[32:35], v[80:83], v[64:79]
    ds_read_b128 v[80:83], v52 offset:384
    s_waitcnt lgkmcnt(3)
    v_mfma_f32_32x32x16_bf16 v[64:79], a[36:39], v[84:87], v[64:79]
    ds_read_b128 v[84:87], v53 offset:384
    s_waitcnt lgkmcnt(3)
    v_mfma_f32_32x32x16_bf16 v[64:79], a[40:43], v[88:91], v[64:79]
    ds_read_b128 v[88:91], v54 offset:384
    s_waitcnt lgkmcnt(3)
    v_mfma_f32_32x32x16_bf16 v[64:79], a[44:47], v[92:95], v[64:79]
    ds_read_b128 v[92:95], v55 offset:384
    s_waitcnt lgkmcnt(3)
    v_mfma_f32_32x32x16_bf16 v[64:79], a[48:51], v[80:83], v[64:79]
    ds_read_b128 v[80:83], v52 offset:512
    s_waitcnt lgkmcnt(3)
    v_mfma_f32_32x32x16_bf16 v[64:79], a[52:55], v[84:87], v[64:79]
    ds_read_b128 v[84:87], v53 offset:512
    s_waitcnt lgkmcnt(3)
    v_mfma_f32_32x32x16_bf16 v[64:79], a[56:59], v[88:91], v[64:79]
    ds_read_b128 v[88:91], v54 offset:512
    s_waitcnt lgkmcnt(3)
    v_mfma_f32_32x32x16_bf16 v[64:79], a[60:63], v[92:95], v[64:79]
    ds_read_b128 v[92:95], v55 offset:512
    s_waitcnt lgkmcnt(3)
    v_mfma_f32_32x32x16_bf16 v[64:79], a[64:67], v[80:83], v[64:79]
    ds_read_b128 v[80:83], v52 offset:640
    s_waitcnt lgkmcnt(3)
    v_mfma_f32_32x32x16_bf16 v[64:79], a[68:71], v[84:87], v[64:79]
    ds_read_b128 v[84:87], v53 offset:640
    s_waitcnt lgkmcnt(3)
    v_mfma_f32_32x32x16_bf16 v[64:79], a[72:75], v[88:91], v[64:79]
    ds_read_b128 v[88:91], v54 offset:640
    s_waitcnt lgkmcnt(3)
    v_mfma_f32_32x32x16_bf16 v[64:79], a[76:79], v[92:95], v[64:79]
    ds_read_b128 v[92:95], v55 offset:640
    s_waitcnt lgkmcnt(3)
    v_mfma_f32_32x32x16_bf16 v[64:79], a[80:83], v[80:83], v[64:79]
    ds_read_b128 v[80:83], v52 offset:768
    s_waitcnt lgkmcnt(3)
    v_mfma_f32_32x32x16_bf16 v[64:79], a[84:87], v[84:87], v[64:79]
    ds_read_b128 v[84:87], v53 offset:768
    s_waitcnt lgkmcnt(3)
    v_mfma_f32_32x32x16_bf16 v[64:79], a[88:91], v[88:91], v[64:79]
    ds_read_b128 v[88:91], v54 offset:768
    s_waitcnt lgkmcnt(3)
    v_mfma_f32_32x32x16_bf16 v[64:79], a[92:95], v[92:95], v[64:79]
    ds_read_b128 v[92:95], v55 offset:768
    s_waitcnt lgkmcnt(3)
    v_mfma_f32_32x32x16_bf16 v[64:79], a[96:99], v[80:83], v[64:79]
    ds_read_b128 v[80:83], v52 offset:896
    s_waitcnt lgkmcnt(3)
    v_mfma_f32_32x32x16_bf16 v[64:79], a[100:103], v[84:87], v[64:79]
    ds_read_b128 v[84:87], v53 offset:896
    s_waitcnt lgkmcnt(3)
    v_mfma_f32_32x32x16_bf16 v[64:79], a[104:107], v[88:91], v[64:79]
    ds_read_b128 v[88:91], v54 offset:896
    s_waitcnt lgkmcnt(3)
    v_mfma_f32_32x32x16_bf16 v[64:79], a[108:111], v[92:95], v[64:79]
    ds_read_b128 v[92:95], v55 offset:896
    s_waitcnt lgkmcnt(3)
    v_mfma_f32_32x32x16_bf16 v[64:79], a[112:115], v[80:83], v[64:79]
    ds_read_b128 v[80:83], v52 offset:1024
    s_waitcnt lgkmcnt(3)
    v_mfma_f32_32x32x16_bf16 v[64:79], a[116:119], v[84:87], v[64:79]
    ds_read_b128 v[84:87], v53 offset:1024
    s_waitcnt lgkmcnt(3)
    v_mfma_f32_32x32x16_bf16 v[64:79], a[120:123], v[88:91], v[64:79]
    ds_read_b128 v[88:91], v54 offset:1024
    s_waitcnt lgkmcnt(3)
    v_mfma_f32_32x32x16_bf16 v[64:79], a[124:127], v[92:95], v[64:79]
    ds_read_b128 v[92:95], v55 offset:1024
    s_waitcnt lgkmcnt(3)
    v_mfma_f32_32x32x16_bf16 v[64:79], a[128:131], v[80:83], v[64:79]
    s_waitcnt lgkmcnt(2)
    v_mfma_f32_32x32x16_bf16 v[64:79], a[132:135], v[84:87], v[64:79]
    s_waitcnt lgkmcnt(1)
    v_mfma_f32_32x32x16_bf16 v[64:79], a[136:139], v[88:91], v[64:79]
    s_waitcnt lgkmcnt(0)
    v_mfma_f32_32x32x16_bf16 v[64:79], a[140:143], v[92:95], v[64:79]
    s_nop 15
    s_mul_i32 s16, s12, 5
    s_add_u32 s16, s16, s72
    s_mul_i32 s16, s16, 49152
    s_add_u32 s52, s4, 0x8000000
    s_addc_u32 s53, s5, 0
    s_add_u32 s52, s52, s16
    s_addc_u32 s53, s53, 0
    s_lshl_b32 s17, s70, 14
    s_add_u32 s54, s52, s17
    s_addc_u32 s55, s53, 0
    global_store_dwordx4 v57, v[64:67], s[54:55] offset:0 sc1
    global_store_dwordx4 v57, v[68:71], s[54:55] offset:1024 sc1
    global_store_dwordx4 v57, v[72:75], s[54:55] offset:2048 sc1
    global_store_dwordx4 v57, v[76:79], s[54:55] offset:3072 sc1
    s_lshl_b32 s31, s12, 7
    s_lshl_b32 s16, s72, 2
    s_add_u32 s31, s31, s16
    s_add_u32 s31, s31, 0x7410000
    s_waitcnt vmcnt(0)
    s_barrier
    s_cmp_lg_u32 s10, 0
    s_cbranch_scc1 Lsg_89
    s_mov_b64 exec, 1
    v_mov_b32 v20, s31
    v_mov_b32 v21, 1
    global_atomic_add v22, v20, v21, s[4:5] sc0
    s_waitcnt vmcnt(0)
    v_mov_b32 v20, 159776
    ds_write_b32 v20, v22
    s_waitcnt lgkmcnt(0)
    s_mov_b64 exec, -1
Lsg_89:
    s_barrier
    v_mov_b32 v20, 159776
    ds_read_b32 v22, v20
    s_waitcnt lgkmcnt(0)
    v_readfirstlane_b32 s33, v22
    s_nop 3
    s_cmp_lg_u32 s33, 2
    s_cbranch_scc1 Lnl_90
    s_mov_b32 s17, 0
    s_add_u32 s54, s52, s17
    s_addc_u32 s55, s53, 0
    global_load_dwordx4 v[96:99], v57, s[54:55] offset:0 sc1
    global_load_dwordx4 v[100:103], v57, s[54:55] offset:1024 sc1
    global_load_dwordx4 v[104:107], v57, s[54:55] offset:2048 sc1
    global_load_dwordx4 v[108:111], v57, s[54:55] offset:3072 sc1
    s_mov_b32 s17, 16384
    s_add_u32 s54, s52, s17
    s_addc_u32 s55, s53, 0
    global_load_dwordx4 v[112:115], v57, s[54:55] offset:0 sc1
    global_load_dwordx4 v[116:119], v57, s[54:55] offset:1024 sc1
    global_load_dwordx4 v[120:123], v57, s[54:55] offset:2048 sc1
    global_load_dwordx4 v[124:127], v57, s[54:55] offset:3072 sc1
    s_mov_b32 s17, 32768
    s_add_u32 s54, s52, s17
    s_addc_u32 s55, s53, 0
    global_load_dwordx4 v[128:131], v57, s[54:55] offset:0 sc1
    global_load_dwordx4 v[132:135], v57, s[54:55] offset:1024 sc1
    global_load_dwordx4 v[136:139], v57, s[54:55] offset:2048 sc1
    global_load_dwordx4 v[140:143], v57, s[54:55] offset:3072 sc1
    s_mul_i32 s16, s12, 40960
    s_add_u32 s50, s4, 0x5400000
    s_addc_u32 s51, s5, 0
    s_add_u32 s50, s50, s16
    s_addc_u32 s51, s51, 0
    s_add_u32 s54, s74, s16
    s_addc_u32 s55, s75, 0
    global_load_dwordx4 v[144:147], v56, s[50:51] offset:0 sc1
    global_load_dwordx4 v[148:151], v56, s[50:51] offset:32 sc1
    s_waitcnt vmcnt(0)
    v_add_f32 v96, v96, v112
    v_add_f32 v96, v96, v128
    v_add_f32 v97, v97, v113
    v_add_f32 v97, v97, v129
    v_add_f32 v98, v98, v114
    v_add_f32 v98, v98, v130
    v_add_f32 v99, v99, v115
    v_add_f32 v99, v99, v131
    v_add_f32 v100, v100, v116
    v_add_f32 v100, v100, v132
    v_add_f32 v101, v101, v117
    v_add_f32 v101, v101, v133
    v_add_f32 v102, v102, v118
    v_add_f32 v102, v102, v134
    v_add_f32 v103, v103, v119
    v_add_f32 v103, v103, v135
    v_add_f32 v104, v104, v120
    v_add_f32 v104, v104, v136
    v_add_f32 v105, v105, v121
    v_add_f32 v105, v105, v137
    v_add_f32 v106, v106, v122
    v_add_f32 v106, v106, v138
    v_add_f32 v107, v107, v123
    v_add_f32 v107, v107, v139
    v_add_f32 v108, v108, v124
    v_add_f32 v108, v108, v140
    v_add_f32 v109, v109, v125
    v_add_f32 v109, v109, v141
    v_add_f32 v110, v110, v126
    v_add_f32 v110, v110, v142
    v_add_f32 v111, v111, v127
    v_add_f32 v111, v111, v143
    v_cvt_pk_bf16_f32 v24, v96, v97
    v_cvt_pk_bf16_f32 v25, v98, v99
    v_cvt_pk_bf16_f32 v26, v100, v101
    v_cvt_pk_bf16_f32 v27, v102, v103
    s_nop 1
    v_permlane32_swap_b32 v24, v26
    v_permlane32_swap_b32 v25, v27
    v_lshlrev_b32 v10, 16, v24
    v_and_b32 v11, 0xffff0000, v24
    v_lshlrev_b32 v12, 16, v144
    v_and_b32 v13, 0xffff0000, v144
    v_add_f32 v10, v10, v12
    v_add_f32 v11, v11, v13
    v_cvt_pk_bf16_f32 v28, v10, v11
    v_lshlrev_b32 v10, 16, v25
    v_and_b32 v11, 0xffff0000, v25
    v_lshlrev_b32 v12, 16, v145
    v_and_b32 v13, 0xffff0000, v145
    v_add_f32 v10, v10, v12
    v_add_f32 v11, v11, v13
    v_cvt_pk_bf16_f32 v29, v10, v11
    v_lshlrev_b32 v10, 16, v26
    v_and_b32 v11, 0xffff0000, v26
    v_lshlrev_b32 v12, 16, v146
    v_and_b32 v13, 0xffff0000, v146
    v_add_f32 v10, v10, v12
    v_add_f32 v11, v11, v13
    v_cvt_pk_bf16_f32 v30, v10, v11
    v_lshlrev_b32 v10, 16, v27
    v_and_b32 v11, 0xffff0000, v27
    v_lshlrev_b32 v12, 16, v147
    v_and_b32 v13, 0xffff0000, v147
    v_add_f32 v10, v10, v12
    v_add_f32 v11, v11, v13
    v_cvt_pk_bf16_f32 v31, v10, v11
    global_store_dwordx4 v56, v[28:31], s[54:55] offset:0
    s_nop 1
    v_cvt_pk_bf16_f32 v24, v104, v105
    v_cvt_pk_bf16_f32 v25, v106, v107
    v_cvt_pk_bf16_f32 v26, v108, v109
    v_cvt_pk_bf16_f32 v27, v110, v111
    s_nop 1
    v_permlane32_swap_b32 v24, v26
    v_permlane32_swap_b32 v25, v27
    v_lshlrev_b32 v10, 16, v24
    v_and_b32 v11, 0xffff0000, v24
    v_lshlrev_b32 v12, 16, v148
    v_and_b32 v13, 0xffff0000, v148
    v_add_f32 v10, v10, v12
    v_add_f32 v11, v11, v13
    v_cvt_pk_bf16_f32 v28, v10, v11
    v_lshlrev_b32 v10, 16, v25
    v_and_b32 v11, 0xffff0000, v25
    v_lshlrev_b32 v12, 16, v149
    v_and_b32 v13, 0xffff0000, v149
    v_add_f32 v10, v10, v12
    v_add_f32 v11, v11, v13
    v_cvt_pk_bf16_f32 v29, v10, v11
    v_lshlrev_b32 v10, 16, v26
    v_and_b32 v11, 0xffff0000, v26
    v_lshlrev_b32 v12, 16, v150
    v_and_b32 v13, 0xffff0000, v150
    v_add_f32 v10, v10, v12
    v_add_f32 v11, v11, v13
    v_cvt_pk_bf16_f32 v30, v10, v11
    v_lshlrev_b32 v10, 16, v27
    v_and_b32 v11, 0xffff0000, v27
    v_lshlrev_b32 v12, 16, v151
    v_and_b32 v13, 0xffff0000, v151
    v_add_f32 v10, v10, v12
    v_add_f32 v11, v11, v13
    v_cvt_pk_bf16_f32 v31, v10, v11
    global_store_dwordx4 v56, v[28:31], s[54:55] offset:32
    s_nop 1
Lnl_90:
    s_add_u32 s12, s12, 3
    s_cmp_lt_u32 s12, 64
    s_cbranch_scc1 Ldn_83
    s_branch Lroles_11
Lendf_3:
    s_endpgm
Lchain_9:
    s_load_dwordx2 s[8:9], s[0:1], 8
    s_load_dwordx2 s[40:41], s[0:1], 16
    s_load_dwordx2 s[42:43], s[0:1], 24
    s_load_dwordx2 s[44:45], s[0:1], 32
    s_load_dwordx2 s[46:47], s[0:1], 40
    v_and_b32 v1, 63, v0
    v_lshlrev_b32 v2, 4, v1
    v_and_b32 v14, 15, v1
    v_lshrrev_b32 v15, 4, v1
    v_lshrrev_b32 v16, 3, v14
    v_and_b32 v17, 7, v14
    v_lshlrev_b32 v18, 1, v15
    v_add_u32 v18, v18, v16
    v_lshlrev_b32 v3, 7, v18
    v_lshlrev_b32 v19, 4, v17
    v_add_u32 v3, v3, v19
    v_mov_b32 v4, 0x4444
    v_mov_b32 v19, 0xeeee
    v_cmp_eq_u32 vcc, 1, v16
    s_nop 1
    v_cndmask_b32 v4, v4, v19, vcc
    v_and_b32 v20, 1, v15
    v_lshrrev_b32 v21, 5, v1
    v_lshlrev_b32 v19, 3, v21
    v_add_u32 v19, v19, v16
    s_lshl_b32 s12, s10, 1
    v_add_u32 v19, s12, v19
    v_mul_u32_u24 v5, 4096, v19
    s_lshl_b32 s12, s11, 7
    v_add_u32 v5, s12, v5
    v_lshlrev_b32 v19, 4, v17
    v_add_u32 v5, v5, v19
    v_lshlrev_b32 v19, 3, v20
    v_add_u32 v5, v5, v19
    s_lshl_b32 s16, s10, 5
    s_add_u32 s16, s16, s11
    v_lshlrev_b32 v19, 2, v16
    v_add_u32 v19, v19, v15
    v_lshlrev_b32 v6, 7, v19
    v_lshlrev_b32 v19, 4, v17
    v_add_u32 v6, v6, v19
    s_mul_i32 s12, s16, 4096
    v_add_u32 v6, s12, v6
    v_lshlrev_b32 v19, 1, v20
    v_add_u32 v19, v19, v21
    v_lshlrev_b32 v19, 2, v19
    v_lshlrev_b32 v7, 4, v14
    v_add_u32 v7, v7, v19
    s_lshl_b32 s12, s16, 7
    v_add_u32 v7, s12, v7
    v_lshlrev_b32 v19, 4, v21
    v_add_u32 v19, v19, v14
    s_lshl_b32 s12, s10, 5
    v_add_u32 v19, s12, v19
    v_lshlrev_b32 v8, 4, v19
    v_lshlrev_b32 v19, 3, v20
    v_add_u32 v8, v8, v19
    v_lshrrev_b32 v19, 2, v14
    v_lshlrev_b32 v22, 3, v15
    v_add_u32 v19, v19, v22
    v_lshlrev_b32 v9, 4, v19
    v_and_b32 v19, 1, v1
    v_lshlrev_b32 v19, 3, v19
    v_add_u32 v9, v9, v19
    v_lshlrev_b32 v10, 7, v20
    v_lshlrev_b32 v19, 4, v14
    v_add_u32 v10, v10, v19
    v_lshrrev_b32 v19, 1, v15
    v_lshlrev_b32 v19, 2, v19
    v_add_u32 v10, v10, v19
    s_lshl_b32 s12, s10, 9
    s_add_u32 s12, s12, 18432
    v_add_u32 v10, s12, v10
    v_mul_u32_u24 v79, 1280, v17
    v_lshlrev_b32 v19, 4, v18
    v_add_u32 v79, v79, v19
    s_add_u32 s52, s4, 0x6400000
    s_addc_u32 s53, s5, 0
    s_add_u32 s54, s4, 0x6500000
    s_addc_u32 s55, s5, 0
    v_mov_b32 v48, -1
    v_mov_b32 v49, -1
    v_mov_b32 v50, -1
    v_mov_b32 v51, -1
    s_cmp_ge_u32 s16, 80
    s_cbranch_scc1 Lni_92
    s_mul_i32 s12, s16, 4096
    v_add_u32 v19, s12, v2
    global_store_dwordx4 v19, v[48:51], s[52:53] offset:0
    global_store_dwordx4 v19, v[48:51], s[52:53] offset:1024
    global_store_dwordx4 v19, v[48:51], s[52:53] offset:2048
    global_store_dwordx4 v19, v[48:51], s[52:53] offset:3072
    s_lshl_b32 s12, s16, 7
    v_add_u32 v19, s12, v2
    s_mov_b64 exec, 0xff
    global_store_dwordx4 v19, v[48:51], s[54:55]
    v_add_u32 v19, 10240, v19
    global_store_dwordx4 v19, v[48:51], s[54:55]
    s_mov_b64 exec, -1
Lni_92:
    s_waitcnt vmcnt(0)
    s_barrier
    s_cmp_lg_u32 s10, 0
    s_cbranch_scc1 Lar_93
    s_mov_b64 exec, 1
    v_mov_b32 v48, 36
    v_mov_b32 v49, 1
    global_atomic_add v48, v49, s[6:7]
    s_mov_b64 exec, -1
Lar_93:
    s_lshl_b32 s12, s10, 4
    v_add_u32 v19, s12, v15
    v_lshlrev_b32 v22, 4, v14
    v_lshlrev_b32 v24, 13, v19
    v_add_u32 v24, v24, v22
    v_add_u32 v25, 32768, v24
    v_add_u32 v26, 65536, v24
    v_add_u32 v27, 98304, v24
    v_mul_u32_u24 v28, 1280, v19
    v_add_u32 v28, v28, v22
    v_add_u32 v29, 5120, v28
    v_add_u32 v30, 10240, v28
    v_add_u32 v31, 15360, v28
    v_lshlrev_b32 v23, 1, v20
    v_xor_b32 v23, v23, v14
    v_lshlrev_b32 v23, 4, v23
    v_lshlrev_b32 v32, 8, v19
    v_add_u32 v32, v32, v23
    v_xor_b32 v33, 64, v32
    v_add_u32 v33, 1024, v33
    v_xor_b32 v34, 128, v32
    v_add_u32 v34, 2048, v34
    v_xor_b32 v35, 192, v32
    v_add_u32 v35, 3072, v35
    v_lshrrev_b32 v19, 2, v14
    v_and_b32 v21, 3, v14
    v_lshrrev_b32 v22, 1, v15
    v_lshlrev_b32 v22, 4, v22
    v_lshlrev_b32 v23, 2, v20
    v_add_u32 v22, v22, v23
    v_and_b32 v23, 1, v19
    v_add_u32 v22, v22, v23
    v_lshrrev_b32 v36, 1, v19
    v_lshlrev_b32 v37, 3, v36
    v_add_u32 v22, v22, v37
    v_lshlrev_b32 v22, 8, v22
    v_lshlrev_b32 v36, 1, v36
    v_add_u32 v36, v36, v20
    v_lshlrev_b32 v36, 2, v36
    v_lshlrev_b32 v23, 1, v23
    v_add_u32 v36, v36, v23
    v_lshrrev_b32 v37, 1, v21
    v_and_b32 v38, 1, v21
    v_lshlrev_b32 v38, 3, v38
    v_add_u32 v22, v22, v38
    s_lshl_b32 s12, s10, 2
    s_add_u32 s12, s12, 0
    v_add_u32 v38, s12, v37
    v_xor_b32 v38, v38, v36
    v_lshlrev_b32 v38, 4, v38
    v_add_u32 v40, v22, v38
    s_lshl_b32 s12, s10, 2
    s_add_u32 s12, s12, 2
    v_add_u32 v38, s12, v37
    v_xor_b32 v38, v38, v36
    v_lshlrev_b32 v38, 4, v38
    v_add_u32 v41, v22, v38
    s_lshl_b32 s12, s10, 1
    s_add_u32 s12, s12, 0
    v_add_u32 v38, s12, v37
    v_xor_b32 v38, v38, v36
    v_lshlrev_b32 v38, 4, v38
    v_add_u32 v42, v22, v38
    s_lshl_b32 s12, s10, 1
    s_add_u32 s12, s12, 8
    v_add_u32 v38, s12, v37
    v_xor_b32 v38, v38, v36
    v_lshlrev_b32 v38, 4, v38
    v_add_u32 v43, v22, v38
    s_lshl_b32 s12, s11, 2
    s_add_u32 s12, s12, s10
    s_mul_i32 s12, s12, 18432
    s_add_u32 s48, s4, 0x6600000
    s_addc_u32 s49, s5, 0
    s_add_u32 s48, s48, s12
    s_addc_u32 s49, s49, 0
    s_mul_i32 s17, s10, 34816
    s_add_u32 s17, s17, 24576
    v_add_u32 v11, s17, v2
    s_waitcnt lgkmcnt(0)
    s_lshl_b32 s12, s11, 8
    s_add_u32 s12, s12, 0
    s_add_u32 s50, s40, s12
    s_addc_u32 s51, s41, 0
    global_load_dwordx4 v[44:47], v24, s[50:51]
    global_load_dwordx4 v[48:51], v25, s[50:51]
    global_load_dwordx4 v[52:55], v26, s[50:51]
    global_load_dwordx4 v[56:59], v27, s[50:51]
    s_lshl_b32 s12, s11, 8
    s_add_u32 s12, s12, 1048576
    s_add_u32 s50, s40, s12
    s_addc_u32 s51, s41, 0
    global_load_dwordx4 v[60:63], v24, s[50:51]
    global_load_dwordx4 v[64:67], v25, s[50:51]
    global_load_dwordx4 v[68:71], v26, s[50:51]
    global_load_dwordx4 v[72:75], v27, s[50:51]
    s_waitcnt vmcnt(4)
    ds_write_b128 v32, v[44:47]
    ds_write_b128 v33, v[48:51]
    ds_write_b128 v34, v[52:55]
    ds_write_b128 v35, v[56:59]
    s_waitcnt lgkmcnt(0)
    s_barrier
    ds_read_b64_tr_b16 v[44:45], v40 offset:0
    ds_read_b64_tr_b16 v[46:47], v40 offset:512
    ds_read_b64_tr_b16 v[48:49], v40 offset:8192
    ds_read_b64_tr_b16 v[50:51], v40 offset:8704
    ds_read_b64_tr_b16 v[52:53], v41 offset:0
    ds_read_b64_tr_b16 v[54:55], v41 offset:512
    ds_read_b64_tr_b16 v[56:57], v41 offset:8192
    ds_read_b64_tr_b16 v[58:59], v41 offset:8704
    s_waitcnt lgkmcnt(0)
    v_add_u32 v38, 0, v2
    global_store_dwordx4 v38, v[44:47], s[48:49]
    global_store_dwordx4 v38, v[48:51], s[48:49] offset:1024
    v_add_u32 v38, 2048, v2
    global_store_dwordx4 v38, v[52:55], s[48:49]
    global_store_dwordx4 v38, v[56:59], s[48:49] offset:1024
    s_waitcnt vmcnt(0)
    s_waitcnt lgkmcnt(0)
    s_barrier
    s_lshl_b32 s12, s11, 8
    s_add_u32 s12, s12, 1572864
    s_add_u32 s50, s40, s12
    s_addc_u32 s51, s41, 0
    global_load_dwordx4 v[44:47], v24, s[50:51]
    global_load_dwordx4 v[48:51], v25, s[50:51]
    global_load_dwordx4 v[52:55], v26, s[50:51]
    global_load_dwordx4 v[56:59], v27, s[50:51]
    s_waitcnt vmcnt(4)
    ds_write_b128 v32, v[60:63]
    ds_write_b128 v33, v[64:67]
    ds_write_b128 v34, v[68:71]
    ds_write_b128 v35, v[72:75]
    s_waitcnt lgkmcnt(0)
    s_barrier
    ds_read_b64_tr_b16 v[96:97], v40 offset:0
    ds_read_b64_tr_b16 v[98:99], v40 offset:512
    ds_read_b64_tr_b16 v[100:101], v40 offset:8192
    ds_read_b64_tr_b16 v[102:103], v40 offset:8704
    ds_read_b64_tr_b16 v[104:105], v41 offset:0
    ds_read_b64_tr_b16 v[106:107], v41 offset:512
    ds_read_b64_tr_b16 v[108:109], v41 offset:8192
    ds_read_b64_tr_b16 v[110:111], v41 offset:8704
    s_waitcnt lgkmcnt(0)
    s_waitcnt lgkmcnt(0)
    s_barrier
    s_lshl_b32 s12, s11, 8
    s_add_u32 s12, s12, 2097152
    s_add_u32 s50, s40, s12
    s_addc_u32 s51, s41, 0
    global_load_dwordx4 v[60:63], v24, s[50:51]
    global_load_dwordx4 v[64:67], v25, s[50:51]
    global_load_dwordx4 v[68:71], v26, s[50:51]
    global_load_dwordx4 v[72:75], v27, s[50:51]
    s_waitcnt vmcnt(4)
    ds_write_b128 v32, v[44:47]
    ds_write_b128 v33, v[48:51]
    ds_write_b128 v34, v[52:55]
    ds_write_b128 v35, v[56:59]
    s_waitcnt lgkmcnt(0)
    s_barrier
    ds_read_b64_tr_b16 v[112:113], v40 offset:0
    ds_read_b64_tr_b16 v[114:115], v40 offset:512
    ds_read_b64_tr_b16 v[116:117], v40 offset:8192
    ds_read_b64_tr_b16 v[118:119], v40 offset:8704
    ds_read_b64_tr_b16 v[52:53], v41 offset:0
    ds_read_b64_tr_b16 v[54:55], v41 offset:512
    ds_read_b64_tr_b16 v[56:57], v41 offset:8192
    ds_read_b64_tr_b16 v[58:59], v41 offset:8704
    s_waitcnt lgkmcnt(0)
    ds_write_b128 v11, v[52:55] offset:4096
    ds_write_b128 v11, v[56:59] offset:5120
    s_waitcnt lgkmcnt(0)
    s_barrier
    s_lshl_b32 s12, s11, 8
    s_add_u32 s12, s12, 2621440
    s_add_u32 s50, s40, s12
    s_addc_u32 s51, s41, 0
    global_load_dwordx4 v[44:47], v24, s[50:51]
    global_load_dwordx4 v[48:51], v25, s[50:51]
    global_load_dwordx4 v[52:55], v26, s[50:51]
    global_load_dwordx4 v[56:59], v27, s[50:51]
    s_waitcnt vmcnt(4)
    ds_write_b128 v32, v[60:63]
    ds_write_b128 v33, v[64:67]
    ds_write_b128 v34, v[68:71]
    ds_write_b128 v35, v[72:75]
    s_waitcnt lgkmcnt(0)
    s_barrier
    ds_read_b64_tr_b16 v[120:121], v40 offset:0
    ds_read_b64_tr_b16 v[122:123], v40 offset:512
    ds_read_b64_tr_b16 v[124:125], v40 offset:8192
    ds_read_b64_tr_b16 v[126:127], v40 offset:8704
    ds_read_b64_tr_b16 v[128:129], v41 offset:0
    ds_read_b64_tr_b16 v[130:131], v41 offset:512
    ds_read_b64_tr_b16 v[132:133], v41 offset:8192
    ds_read_b64_tr_b16 v[134:135], v41 offset:8704
    s_waitcnt lgkmcnt(0)
    s_waitcnt lgkmcnt(0)
    s_barrier
    s_lshl_b32 s12, s11, 8
    s_add_u32 s12, s12, 3145728
    s_add_u32 s50, s40, s12
    s_addc_u32 s51, s41, 0
    global_load_dwordx4 v[60:63], v24, s[50:51]
    global_load_dwordx4 v[64:67], v25, s[50:51]
    global_load_dwordx4 v[68:71], v26, s[50:51]
    global_load_dwordx4 v[72:75], v27, s[50:51]
    s_waitcnt vmcnt(4)
    ds_write_b128 v32, v[44:47]
    ds_write_b128 v33, v[48:51]
    ds_write_b128 v34, v[52:55]
    ds_write_b128 v35, v[56:59]
    s_waitcnt lgkmcnt(0)
    s_barrier
    ds_read_b64_tr_b16 v[44:45], v40 offset:0
    ds_read_b64_tr_b16 v[46:47], v40 offset:512
    ds_read_b64_tr_b16 v[48:49], v40 offset:8192
    ds_read_b64_tr_b16 v[50:51], v40 offset:8704
    ds_read_b64_tr_b16 v[136:137], v41 offset:0
    ds_read_b64_tr_b16 v[138:139], v41 offset:512
    ds_read_b64_tr_b16 v[140:141], v41 offset:8192
    ds_read_b64_tr_b16 v[142:143], v41 offset:8704
    s_waitcnt lgkmcnt(0)
    ds_write_b128 v11, v[44:47] offset:10240
    ds_write_b128 v11, v[48:51] offset:11264
    s_waitcnt lgkmcnt(0)
    s_barrier
    s_lshl_b32 s12, s11, 8
    s_add_u32 s12, s12, 3670016
    s_add_u32 s50, s40, s12
    s_addc_u32 s51, s41, 0
    global_load_dwordx4 v[44:47], v24, s[50:51]
    global_load_dwordx4 v[48:51], v25, s[50:51]
    global_load_dwordx4 v[52:55], v26, s[50:51]
    global_load_dwordx4 v[56:59], v27, s[50:51]
    s_waitcnt vmcnt(4)
    ds_write_b128 v32, v[60:63]
    ds_write_b128 v33, v[64:67]
    ds_write_b128 v34, v[68:71]
    ds_write_b128 v35, v[72:75]
    s_waitcnt lgkmcnt(0)
    s_barrier
    ds_read_b64_tr_b16 v[144:145], v40 offset:0
    ds_read_b64_tr_b16 v[146:147], v40 offset:512
    ds_read_b64_tr_b16 v[148:149], v40 offset:8192
    ds_read_b64_tr_b16 v[150:151], v40 offset:8704
    ds_read_b64_tr_b16 v[152:153], v41 offset:0
    ds_read_b64_tr_b16 v[154:155], v41 offset:512
    ds_read_b64_tr_b16 v[156:157], v41 offset:8192
    ds_read_b64_tr_b16 v[158:159], v41 offset:8704
    s_waitcnt lgkmcnt(0)
    s_waitcnt lgkmcnt(0)
    s_barrier
    s_lshl_b32 s12, s11, 8
    s_add_u32 s12, s12, 4194304
    s_add_u32 s50, s40, s12
    s_addc_u32 s51, s41, 0
    global_load_dwordx4 v[60:63], v24, s[50:51]
    global_load_dwordx4 v[64:67], v25, s[50:51]
    global_load_dwordx4 v[68:71], v26, s[50:51]
    global_load_dwordx4 v[72:75], v27, s[50:51]
    s_waitcnt vmcnt(4)
    ds_write_b128 v32, v[44:47]
    ds_write_b128 v33, v[48:51]
    ds_write_b128 v34, v[52:55]
    ds_write_b128 v35, v[56:59]
    s_waitcnt lgkmcnt(0)
    s_barrier
    ds_read_b64_tr_b16 v[160:161], v40 offset:0
    ds_read_b64_tr_b16 v[162:163], v40 offset:512
    ds_read_b64_tr_b16 v[164:165], v40 offset:8192
    ds_read_b64_tr_b16 v[166:167], v40 offset:8704
    ds_read_b64_tr_b16 v[52:53], v41 offset:0
    ds_read_b64_tr_b16 v[54:55], v41 offset:512
    ds_read_b64_tr_b16 v[56:57], v41 offset:8192
    ds_read_b64_tr_b16 v[58:59], v41 offset:8704
    s_waitcnt lgkmcnt(0)
    ds_write_b128 v11, v[52:55] offset:16384
    ds_write_b128 v11, v[56:59] offset:17408
    s_waitcnt lgkmcnt(0)
    s_barrier
    s_lshl_b32 s12, s11, 8
    s_add_u32 s12, s12, 4718592
    s_add_u32 s50, s40, s12
    s_addc_u32 s51, s41, 0
    global_load_dwordx4 v[44:47], v24, s[50:51]
    global_load_dwordx4 v[48:51], v25, s[50:51]
    global_load_dwordx4 v[52:55], v26, s[50:51]
    global_load_dwordx4 v[56:59], v27, s[50:51]
    s_waitcnt vmcnt(4)
    ds_write_b128 v32, v[60:63]
    ds_write_b128 v33, v[64:67]
    ds_write_b128 v34, v[68:71]
    ds_write_b128 v35, v[72:75]
    s_waitcnt lgkmcnt(0)
    s_barrier
    ds_read_b64_tr_b16 v[168:169], v40 offset:0
    ds_read_b64_tr_b16 v[170:171], v40 offset:512
    ds_read_b64_tr_b16 v[172:173], v40 offset:8192
    ds_read_b64_tr_b16 v[174:175], v40 offset:8704
    ds_read_b64_tr_b16 v[176:177], v41 offset:0
    ds_read_b64_tr_b16 v[178:179], v41 offset:512
    ds_read_b64_tr_b16 v[180:181], v41 offset:8192
    ds_read_b64_tr_b16 v[182:183], v41 offset:8704
    s_waitcnt lgkmcnt(0)
    s_waitcnt lgkmcnt(0)
    s_barrier
    s_lshl_b32 s12, s11, 8
    s_add_u32 s12, s12, 0
    s_add_u32 s50, s42, s12
    s_addc_u32 s51, s43, 0
    global_load_dwordx4 v[60:63], v24, s[50:51]
    global_load_dwordx4 v[64:67], v25, s[50:51]
    global_load_dwordx4 v[68:71], v26, s[50:51]
    global_load_dwordx4 v[72:75], v27, s[50:51]
    s_waitcnt vmcnt(4)
    ds_write_b128 v32, v[44:47]
    ds_write_b128 v33, v[48:51]
    ds_write_b128 v34, v[52:55]
    ds_write_b128 v35, v[56:59]
    s_waitcnt lgkmcnt(0)
    s_barrier
    ds_read_b64_tr_b16 v[184:185], v40 offset:0
    ds_read_b64_tr_b16 v[186:187], v40 offset:512
    ds_read_b64_tr_b16 v[188:189], v40 offset:8192
    ds_read_b64_tr_b16 v[190:191], v40 offset:8704
    ds_read_b64_tr_b16 v[192:193], v41 offset:0
    ds_read_b64_tr_b16 v[194:195], v41 offset:512
    ds_read_b64_tr_b16 v[196:197], v41 offset:8192
    ds_read_b64_tr_b16 v[198:199], v41 offset:8704
    s_waitcnt lgkmcnt(0)
    s_waitcnt lgkmcnt(0)
    s_barrier
    s_lshl_b32 s12, s11, 8
    s_add_u32 s12, s12, 524288
    s_add_u32 s50, s42, s12
    s_addc_u32 s51, s43, 0
    global_load_dwordx4 v[44:47], v24, s[50:51]
    global_load_dwordx4 v[48:51], v25, s[50:51]
    global_load_dwordx4 v[52:55], v26, s[50:51]
    global_load_dwordx4 v[56:59], v27, s[50:51]
    s_waitcnt vmcnt(4)
    ds_write_b128 v32, v[60:63]
    ds_write_b128 v33, v[64:67]
    ds_write_b128 v34, v[68:71]
    ds_write_b128 v35, v[72:75]
    s_waitcnt lgkmcnt(0)
    s_barrier
    ds_read_b64_tr_b16 v[60:61], v40 offset:0
    ds_read_b64_tr_b16 v[62:63], v40 offset:512
    ds_read_b64_tr_b16 v[64:65], v40 offset:8192
    ds_read_b64_tr_b16 v[66:67], v40 offset:8704
    ds_read_b64_tr_b16 v[68:69], v41 offset:0
    ds_read_b64_tr_b16 v[70:71], v41 offset:512
    ds_read_b64_tr_b16 v[72:73], v41 offset:8192
    ds_read_b64_tr_b16 v[74:75], v41 offset:8704
    s_waitcnt lgkmcnt(0)
    v_add_u32 v38, 4096, v2
    global_store_dwordx4 v38, v[60:63], s[48:49]
    global_store_dwordx4 v38, v[64:67], s[48:49] offset:1024
    v_add_u32 v38, 6144, v2
    global_store_dwordx4 v38, v[68:71], s[48:49]
    global_store_dwordx4 v38, v[72:75], s[48:49] offset:1024
    s_waitcnt vmcnt(0)
    s_waitcnt lgkmcnt(0)
    s_barrier
    s_lshl_b32 s12, s11, 8
    s_add_u32 s12, s12, 1048576
    s_add_u32 s50, s42, s12
    s_addc_u32 s51, s43, 0
    global_load_dwordx4 v[60:63], v24, s[50:51]
    global_load_dwordx4 v[64:67], v25, s[50:51]
    global_load_dwordx4 v[68:71], v26, s[50:51]
    global_load_dwordx4 v[72:75], v27, s[50:51]
    s_waitcnt vmcnt(4)
    ds_write_b128 v32, v[44:47]
    ds_write_b128 v33, v[48:51]
    ds_write_b128 v34, v[52:55]
    ds_write_b128 v35, v[56:59]
    s_waitcnt lgkmcnt(0)
    s_barrier
    ds_read_b64_tr_b16 v[200:201], v40 offset:0
    ds_read_b64_tr_b16 v[202:203], v40 offset:512
    ds_read_b64_tr_b16 v[204:205], v40 offset:8192
    ds_read_b64_tr_b16 v[206:207], v40 offset:8704
    ds_read_b64_tr_b16 v[208:209], v41 offset:0
    ds_read_b64_tr_b16 v[210:211], v41 offset:512
    ds_read_b64_tr_b16 v[212:213], v41 offset:8192
    ds_read_b64_tr_b16 v[214:215], v41 offset:8704
    s_waitcnt lgkmcnt(0)
    s_waitcnt lgkmcnt(0)
    s_barrier
    s_lshl_b32 s12, s11, 8
    s_add_u32 s12, s12, 1572864
    s_add_u32 s50, s42, s12
    s_addc_u32 s51, s43, 0
    global_load_dwordx4 v[44:47], v24, s[50:51]
    global_load_dwordx4 v[48:51], v25, s[50:51]
    global_load_dwordx4 v[52:55], v26, s[50:51]
    global_load_dwordx4 v[56:59], v27, s[50:51]
    s_waitcnt vmcnt(4)
    ds_write_b128 v32, v[60:63]
    ds_write_b128 v33, v[64:67]
    ds_write_b128 v34, v[68:71]
    ds_write_b128 v35, v[72:75]
    s_waitcnt lgkmcnt(0)
    s_barrier
    ds_read_b64_tr_b16 v[60:61], v40 offset:0
    ds_read_b64_tr_b16 v[62:63], v40 offset:512
    ds_read_b64_tr_b16 v[64:65], v40 offset:8192
    ds_read_b64_tr_b16 v[66:67], v40 offset:8704
    ds_read_b64_tr_b16 v[216:217], v41 offset:0
    ds_read_b64_tr_b16 v[218:219], v41 offset:512
    ds_read_b64_tr_b16 v[220:221], v41 offset:8192
    ds_read_b64_tr_b16 v[222:223], v41 offset:8704
    s_waitcnt lgkmcnt(0)
    ds_write_b128 v11, v[60:63] offset:2048
    ds_write_b128 v11, v[64:67] offset:3072
    s_waitcnt lgkmcnt(0)
    s_barrier
    s_lshl_b32 s12, s11, 8
    s_add_u32 s12, s12, 2097152
    s_add_u32 s50, s42, s12
    s_addc_u32 s51, s43, 0
    global_load_dwordx4 v[60:63], v24, s[50:51]
    global_load_dwordx4 v[64:67], v25, s[50:51]
    global_load_dwordx4 v[68:71], v26, s[50:51]
    global_load_dwordx4 v[72:75], v27, s[50:51]
    s_waitcnt vmcnt(4)
    ds_write_b128 v32, v[44:47]
    ds_write_b128 v33, v[48:51]
    ds_write_b128 v34, v[52:55]
    ds_write_b128 v35, v[56:59]
    s_waitcnt lgkmcnt(0)
    s_barrier
    ds_read_b64_tr_b16 v[224:225], v40 offset:0
    ds_read_b64_tr_b16 v[226:227], v40 offset:512
    ds_read_b64_tr_b16 v[228:229], v40 offset:8192
    ds_read_b64_tr_b16 v[230:231], v40 offset:8704
    ds_read_b64_tr_b16 v[232:233], v41 offset:0
    ds_read_b64_tr_b16 v[234:235], v41 offset:512
    ds_read_b64_tr_b16 v[236:237], v41 offset:8192
    ds_read_b64_tr_b16 v[238:239], v41 offset:8704
    s_waitcnt lgkmcnt(0)
    s_waitcnt lgkmcnt(0)
    s_barrier
    s_lshl_b32 s12, s11, 8
    s_add_u32 s12, s12, 2621440
    s_add_u32 s50, s42, s12
    s_addc_u32 s51, s43, 0
    global_load_dwordx4 v[44:47], v24, s[50:51]
    global_load_dwordx4 v[48:51], v25, s[50:51]
    global_load_dwordx4 v[52:55], v26, s[50:51]
    global_load_dwordx4 v[56:59], v27, s[50:51]
    s_waitcnt vmcnt(4)
    ds_write_b128 v32, v[60:63]
    ds_write_b128 v33, v[64:67]
    ds_write_b128 v34, v[68:71]
    ds_write_b128 v35, v[72:75]
    s_waitcnt lgkmcnt(0)
    s_barrier
    ds_read_b64_tr_b16 v[240:241], v40 offset:0
    ds_read_b64_tr_b16 v[242:243], v40 offset:512
    ds_read_b64_tr_b16 v[244:245], v40 offset:8192
    ds_read_b64_tr_b16 v[246:247], v40 offset:8704
    ds_read_b64_tr_b16 v[68:69], v41 offset:0
    ds_read_b64_tr_b16 v[70:71], v41 offset:512
    ds_read_b64_tr_b16 v[72:73], v41 offset:8192
    ds_read_b64_tr_b16 v[74:75], v41 offset:8704
    s_waitcnt lgkmcnt(0)
    ds_write_b128 v11, v[68:71] offset:8192
    ds_write_b128 v11, v[72:75] offset:9216
    s_waitcnt lgkmcnt(0)
    s_barrier
    s_lshl_b32 s12, s11, 8
    s_add_u32 s12, s12, 3145728
    s_add_u32 s50, s42, s12
    s_addc_u32 s51, s43, 0
    global_load_dwordx4 v[60:63], v24, s[50:51]
    global_load_dwordx4 v[64:67], v25, s[50:51]
    global_load_dwordx4 v[68:71], v26, s[50:51]
    global_load_dwordx4 v[72:75], v27, s[50:51]
    s_waitcnt vmcnt(4)
    ds_write_b128 v32, v[44:47]
    ds_write_b128 v33, v[48:51]
    ds_write_b128 v34, v[52:55]
    ds_write_b128 v35, v[56:59]
    s_waitcnt lgkmcnt(0)
    s_barrier
    ds_read_b64_tr_b16 v[248:249], v40 offset:0
    ds_read_b64_tr_b16 v[250:251], v40 offset:512
    ds_read_b64_tr_b16 v[252:253], v40 offset:8192
    ds_read_b64_tr_b16 v[254:255], v40 offset:8704
    ds_read_b64_tr_b16 a[0:1], v41 offset:0
    ds_read_b64_tr_b16 a[2:3], v41 offset:512
    ds_read_b64_tr_b16 a[4:5], v41 offset:8192
    ds_read_b64_tr_b16 a[6:7], v41 offset:8704
    s_waitcnt lgkmcnt(0)
    s_waitcnt lgkmcnt(0)
    s_barrier
    s_lshl_b32 s12, s11, 8
    s_add_u32 s12, s12, 3670016
    s_add_u32 s50, s42, s12
    s_addc_u32 s51, s43, 0
    global_load_dwordx4 v[44:47], v24, s[50:51]
    global_load_dwordx4 v[48:51], v25, s[50:51]
    global_load_dwordx4 v[52:55], v26, s[50:51]
    global_load_dwordx4 v[56:59], v27, s[50:51]
    s_waitcnt vmcnt(4)
    ds_write_b128 v32, v[60:63]
    ds_write_b128 v33, v[64:67]
    ds_write_b128 v34, v[68:71]
    ds_write_b128 v35, v[72:75]
    s_waitcnt lgkmcnt(0)
    s_barrier
    ds_read_b64_tr_b16 a[8:9], v40 offset:0
    ds_read_b64_tr_b16 a[10:11], v40 offset:512
    ds_read_b64_tr_b16 a[12:13], v40 offset:8192
    ds_read_b64_tr_b16 a[14:15], v40 offset:8704
    ds_read_b64_tr_b16 a[16:17], v41 offset:0
    ds_read_b64_tr_b16 a[18:19], v41 offset:512
    ds_read_b64_tr_b16 a[20:21], v41 offset:8192
    ds_read_b64_tr_b16 a[22:23], v41 offset:8704
    s_waitcnt lgkmcnt(0)
    s_waitcnt lgkmcnt(0)
    s_barrier
    s_lshl_b32 s12, s11, 8
    s_add_u32 s12, s12, 4194304
    s_add_u32 s50, s42, s12
    s_addc_u32 s51, s43, 0
    global_load_dwordx4 v[60:63], v24, s[50:51]
    global_load_dwordx4 v[64:67], v25, s[50:51]
    global_load_dwordx4 v[68:71], v26, s[50:51]
    global_load_dwordx4 v[72:75], v27, s[50:51]
    s_waitcnt vmcnt(4)
    ds_write_b128 v32, v[44:47]
    ds_write_b128 v33, v[48:51]
    ds_write_b128 v34, v[52:55]
    ds_write_b128 v35, v[56:59]
    s_waitcnt lgkmcnt(0)
    s_barrier
    ds_read_b64_tr_b16 v[44:45], v40 offset:0
    ds_read_b64_tr_b16 v[46:47], v40 offset:512
    ds_read_b64_tr_b16 v[48:49], v40 offset:8192
    ds_read_b64_tr_b16 v[50:51], v40 offset:8704
    ds_read_b64_tr_b16 a[24:25], v41 offset:0
    ds_read_b64_tr_b16 a[26:27], v41 offset:512
    ds_read_b64_tr_b16 a[28:29], v41 offset:8192
    ds_read_b64_tr_b16 a[30:31], v41 offset:8704
    s_waitcnt lgkmcnt(0)
    ds_write_b128 v11, v[44:47] offset:14336
    ds_write_b128 v11, v[48:51] offset:15360
    s_waitcnt lgkmcnt(0)
    s_barrier
    s_lshl_b32 s12, s11, 8
    s_add_u32 s12, s12, 4718592
    s_add_u32 s50, s42, s12
    s_addc_u32 s51, s43, 0
    global_load_dwordx4 v[44:47], v24, s[50:51]
    global_load_dwordx4 v[48:51], v25, s[50:51]
    global_load_dwordx4 v[52:55], v26, s[50:51]
    global_load_dwordx4 v[56:59], v27, s[50:51]
    s_waitcnt vmcnt(4)
    ds_write_b128 v32, v[60:63]
    ds_write_b128 v33, v[64:67]
    ds_write_b128 v34, v[68:71]
    ds_write_b128 v35, v[72:75]
    s_waitcnt lgkmcnt(0)
    s_barrier
    ds_read_b64_tr_b16 a[32:33], v40 offset:0
    ds_read_b64_tr_b16 a[34:35], v40 offset:512
    ds_read_b64_tr_b16 a[36:37], v40 offset:8192
    ds_read_b64_tr_b16 a[38:39], v40 offset:8704
    ds_read_b64_tr_b16 a[40:41], v41 offset:0
    ds_read_b64_tr_b16 a[42:43], v41 offset:512
    ds_read_b64_tr_b16 a[44:45], v41 offset:8192
    ds_read_b64_tr_b16 a[46:47], v41 offset:8704
    s_waitcnt lgkmcnt(0)
    s_waitcnt lgkmcnt(0)
    s_barrier
    s_lshl_b32 s12, s11, 8
    s_add_u32 s12, s12, 0
    s_add_u32 s50, s44, s12
    s_addc_u32 s51, s45, 0
    global_load_dwordx4 v[60:63], v24, s[50:51]
    global_load_dwordx4 v[64:67], v25, s[50:51]
    global_load_dwordx4 v[68:71], v26, s[50:51]
    global_load_dwordx4 v[72:75], v27, s[50:51]
    s_waitcnt vmcnt(4)
    ds_write_b128 v32, v[44:47]
    ds_write_b128 v33, v[48:51]
    ds_write_b128 v34, v[52:55]
    ds_write_b128 v35, v[56:59]
    s_waitcnt lgkmcnt(0)
    s_barrier
    ds_read_b64_tr_b16 a[48:49], v40 offset:0
    ds_read_b64_tr_b16 a[50:51], v40 offset:512
    ds_read_b64_tr_b16 a[52:53], v40 offset:8192
    ds_read_b64_tr_b16 a[54:55], v40 offset:8704
    ds_read_b64_tr_b16 v[52:53], v41 offset:0
    ds_read_b64_tr_b16 v[54:55], v41 offset:512
    ds_read_b64_tr_b16 v[56:57], v41 offset:8192
    ds_read_b64_tr_b16 v[58:59], v41 offset:8704
    s_waitcnt lgkmcnt(0)
    ds_write_b128 v11, v[52:55] offset:20480
    ds_write_b128 v11, v[56:59] offset:21504
    s_waitcnt lgkmcnt(0)
    s_barrier
    s_lshl_b32 s12, s11, 8
    s_add_u32 s12, s12, 524288
    s_add_u32 s50, s44, s12
    s_addc_u32 s51, s45, 0
    global_load_dwordx4 v[44:47], v24, s[50:51]
    global_load_dwordx4 v[48:51], v25, s[50:51]
    global_load_dwordx4 v[52:55], v26, s[50:51]
    global_load_dwordx4 v[56:59], v27, s[50:51]
    s_waitcnt vmcnt(4)
    ds_write_b128 v32, v[60:63]
    ds_write_b128 v33, v[64:67]
    ds_write_b128 v34, v[68:71]
    ds_write_b128 v35, v[72:75]
    s_waitcnt lgkmcnt(0)
    s_barrier
    ds_read_b64_tr_b16 a[56:57], v40 offset:0
    ds_read_b64_tr_b16 a[58:59], v40 offset:512
    ds_read_b64_tr_b16 a[60:61], v40 offset:8192
    ds_read_b64_tr_b16 a[62:63], v40 offset:8704
    ds_read_b64_tr_b16 a[64:65], v41 offset:0
    ds_read_b64_tr_b16 a[66:67], v41 offset:512
    ds_read_b64_tr_b16 a[68:69], v41 offset:8192
    ds_read_b64_tr_b16 a[70:71], v41 offset:8704
    s_waitcnt lgkmcnt(0)
    s_waitcnt lgkmcnt(0)
    s_barrier
    s_lshl_b32 s12, s11, 8
    s_add_u32 s12, s12, 1048576
    s_add_u32 s50, s44, s12
    s_addc_u32 s51, s45, 0
    global_load_dwordx4 v[60:63], v24, s[50:51]
    global_load_dwordx4 v[64:67], v25, s[50:51]
    global_load_dwordx4 v[68:71], v26, s[50:51]
    global_load_dwordx4 v[72:75], v27, s[50:51]
    s_waitcnt vmcnt(4)
    ds_write_b128 v32, v[44:47]
    ds_write_b128 v33, v[48:51]
    ds_write_b128 v34, v[52:55]
    ds_write_b128 v35, v[56:59]
    s_waitcnt lgkmcnt(0)
    s_barrier
    ds_read_b64_tr_b16 v[44:45], v40 offset:0
    ds_read_b64_tr_b16 v[46:47], v40 offset:512
    ds_read_b64_tr_b16 v[48:49], v40 offset:8192
    ds_read_b64_tr_b16 v[50:51], v40 offset:8704
    ds_read_b64_tr_b16 a[72:73], v41 offset:0
    ds_read_b64_tr_b16 a[74:75], v41 offset:512
    ds_read_b64_tr_b16 a[76:77], v41 offset:8192
    ds_read_b64_tr_b16 a[78:79], v41 offset:8704
    s_waitcnt lgkmcnt(0)
    ds_write_b128 v11, v[44:47] offset:0
    ds_write_b128 v11, v[48:51] offset:1024
    s_waitcnt lgkmcnt(0)
    s_barrier
    s_lshl_b32 s12, s11, 8
    s_add_u32 s12, s12, 1572864
    s_add_u32 s50, s44, s12
    s_addc_u32 s51, s45, 0
    global_load_dwordx4 v[44:47], v24, s[50:51]
    global_load_dwordx4 v[48:51], v25, s[50:51]
    global_load_dwordx4 v[52:55], v26, s[50:51]
    global_load_dwordx4 v[56:59], v27, s[50:51]
    s_waitcnt vmcnt(4)
    ds_write_b128 v32, v[60:63]
    ds_write_b128 v33, v[64:67]
    ds_write_b128 v34, v[68:71]
    ds_write_b128 v35, v[72:75]
    s_waitcnt lgkmcnt(0)
    s_barrier
    ds_read_b64_tr_b16 a[80:81], v40 offset:0
    ds_read_b64_tr_b16 a[82:83], v40 offset:512
    ds_read_b64_tr_b16 a[84:85], v40 offset:8192
    ds_read_b64_tr_b16 a[86:87], v40 offset:8704
    ds_read_b64_tr_b16 a[88:89], v41 offset:0
    ds_read_b64_tr_b16 a[90:91], v41 offset:512
    ds_read_b64_tr_b16 a[92:93], v41 offset:8192
    ds_read_b64_tr_b16 a[94:95], v41 offset:8704
    s_waitcnt lgkmcnt(0)
    s_waitcnt lgkmcnt(0)
    s_barrier
    s_lshl_b32 s12, s11, 8
    s_add_u32 s12, s12, 2097152
    s_add_u32 s50, s44, s12
    s_addc_u32 s51, s45, 0
    global_load_dwordx4 v[60:63], v24, s[50:51]
    global_load_dwordx4 v[64:67], v25, s[50:51]
    global_load_dwordx4 v[68:71], v26, s[50:51]
    global_load_dwordx4 v[72:75], v27, s[50:51]
    s_waitcnt vmcnt(4)
    ds_write_b128 v32, v[44:47]
    ds_write_b128 v33, v[48:51]
    ds_write_b128 v34, v[52:55]
    ds_write_b128 v35, v[56:59]
    s_waitcnt lgkmcnt(0)
    s_barrier
    ds_read_b64_tr_b16 a[96:97], v40 offset:0
    ds_read_b64_tr_b16 a[98:99], v40 offset:512
    ds_read_b64_tr_b16 a[100:101], v40 offset:8192
    ds_read_b64_tr_b16 a[102:103], v40 offset:8704
    ds_read_b64_tr_b16 v[52:53], v41 offset:0
    ds_read_b64_tr_b16 v[54:55], v41 offset:512
    ds_read_b64_tr_b16 v[56:57], v41 offset:8192
    ds_read_b64_tr_b16 v[58:59], v41 offset:8704
    s_waitcnt lgkmcnt(0)
    ds_write_b128 v11, v[52:55] offset:6144
    ds_write_b128 v11, v[56:59] offset:7168
    s_waitcnt lgkmcnt(0)
    s_barrier
    s_lshl_b32 s12, s11, 8
    s_add_u32 s12, s12, 2621440
    s_add_u32 s50, s44, s12
    s_addc_u32 s51, s45, 0
    global_load_dwordx4 v[44:47], v24, s[50:51]
    global_load_dwordx4 v[48:51], v25, s[50:51]
    global_load_dwordx4 v[52:55], v26, s[50:51]
    global_load_dwordx4 v[56:59], v27, s[50:51]
    s_waitcnt vmcnt(4)
    ds_write_b128 v32, v[60:63]
    ds_write_b128 v33, v[64:67]
    ds_write_b128 v34, v[68:71]
    ds_write_b128 v35, v[72:75]
    s_waitcnt lgkmcnt(0)
    s_barrier
    ds_read_b64_tr_b16 a[104:105], v40 offset:0
    ds_read_b64_tr_b16 a[106:107], v40 offset:512
    ds_read_b64_tr_b16 a[108:109], v40 offset:8192
    ds_read_b64_tr_b16 a[110:111], v40 offset:8704
    ds_read_b64_tr_b16 a[112:113], v41 offset:0
    ds_read_b64_tr_b16 a[114:115], v41 offset:512
    ds_read_b64_tr_b16 a[116:117], v41 offset:8192
    ds_read_b64_tr_b16 a[118:119], v41 offset:8704
    s_waitcnt lgkmcnt(0)
    s_waitcnt lgkmcnt(0)
    s_barrier
    s_lshl_b32 s12, s11, 8
    s_add_u32 s12, s12, 3145728
    s_add_u32 s50, s44, s12
    s_addc_u32 s51, s45, 0
    global_load_dwordx4 v[60:63], v24, s[50:51]
    global_load_dwordx4 v[64:67], v25, s[50:51]
    global_load_dwordx4 v[68:71], v26, s[50:51]
    global_load_dwordx4 v[72:75], v27, s[50:51]
    s_waitcnt vmcnt(4)
    ds_write_b128 v32, v[44:47]
    ds_write_b128 v33, v[48:51]
    ds_write_b128 v34, v[52:55]
    ds_write_b128 v35, v[56:59]
    s_waitcnt lgkmcnt(0)
    s_barrier
    ds_read_b64_tr_b16 v[44:45], v40 offset:0
    ds_read_b64_tr_b16 v[46:47], v40 offset:512
    ds_read_b64_tr_b16 v[48:49], v40 offset:8192
    ds_read_b64_tr_b16 v[50:51], v40 offset:8704
    ds_read_b64_tr_b16 v[52:53], v41 offset:0
    ds_read_b64_tr_b16 v[54:55], v41 offset:512
    ds_read_b64_tr_b16 v[56:57], v41 offset:8192
    ds_read_b64_tr_b16 v[58:59], v41 offset:8704
    s_waitcnt lgkmcnt(0)
    v_add_u32 v38, 8192, v2
    global_store_dwordx4 v38, v[44:47], s[48:49]
    global_store_dwordx4 v38, v[48:51], s[48:49] offset:1024
    v_add_u32 v38, 10240, v2
    global_store_dwordx4 v38, v[52:55], s[48:49]
    global_store_dwordx4 v38, v[56:59], s[48:49] offset:1024
    s_waitcnt vmcnt(0)
    s_waitcnt lgkmcnt(0)
    s_barrier
    s_lshl_b32 s12, s11, 8
    s_add_u32 s12, s12, 3670016
    s_add_u32 s50, s44, s12
    s_addc_u32 s51, s45, 0
    global_load_dwordx4 v[44:47], v24, s[50:51]
    global_load_dwordx4 v[48:51], v25, s[50:51]
    global_load_dwordx4 v[52:55], v26, s[50:51]
    global_load_dwordx4 v[56:59], v27, s[50:51]
    s_waitcnt vmcnt(4)
    ds_write_b128 v32, v[60:63]
    ds_write_b128 v33, v[64:67]
    ds_write_b128 v34, v[68:71]
    ds_write_b128 v35, v[72:75]
    s_waitcnt lgkmcnt(0)
    s_barrier
    ds_read_b64_tr_b16 v[60:61], v40 offset:0
    ds_read_b64_tr_b16 v[62:63], v40 offset:512
    ds_read_b64_tr_b16 v[64:65], v40 offset:8192
    ds_read_b64_tr_b16 v[66:67], v40 offset:8704
    ds_read_b64_tr_b16 a[120:121], v41 offset:0
    ds_read_b64_tr_b16 a[122:123], v41 offset:512
    ds_read_b64_tr_b16 a[124:125], v41 offset:8192
    ds_read_b64_tr_b16 a[126:127], v41 offset:8704
    s_waitcnt lgkmcnt(0)
    ds_write_b128 v11, v[60:63] offset:12288
    ds_write_b128 v11, v[64:67] offset:13312
    s_waitcnt lgkmcnt(0)
    s_barrier
    s_lshl_b32 s12, s11, 8
    s_add_u32 s12, s12, 4194304
    s_add_u32 s50, s44, s12
    s_addc_u32 s51, s45, 0
    global_load_dwordx4 v[60:63], v24, s[50:51]
    global_load_dwordx4 v[64:67], v25, s[50:51]
    global_load_dwordx4 v[68:71], v26, s[50:51]
    global_load_dwordx4 v[72:75], v27, s[50:51]
    s_waitcnt vmcnt(4)
    ds_write_b128 v32, v[44:47]
    ds_write_b128 v33, v[48:51]
    ds_write_b128 v34, v[52:55]
    ds_write_b128 v35, v[56:59]
    s_waitcnt lgkmcnt(0)
    s_barrier
    ds_read_b64_tr_b16 a[128:129], v40 offset:0
    ds_read_b64_tr_b16 a[130:131], v40 offset:512
    ds_read_b64_tr_b16 a[132:133], v40 offset:8192
    ds_read_b64_tr_b16 a[134:135], v40 offset:8704
    ds_read_b64_tr_b16 a[136:137], v41 offset:0
    ds_read_b64_tr_b16 a[138:139], v41 offset:512
    ds_read_b64_tr_b16 a[140:141], v41 offset:8192
    ds_read_b64_tr_b16 a[142:143], v41 offset:8704
    s_waitcnt lgkmcnt(0)
    s_waitcnt lgkmcnt(0)
    s_barrier
    s_lshl_b32 s12, s11, 8
    s_add_u32 s12, s12, 4718592
    s_add_u32 s50, s44, s12
    s_addc_u32 s51, s45, 0
    global_load_dwordx4 v[44:47], v24, s[50:51]
    global_load_dwordx4 v[48:51], v25, s[50:51]
    global_load_dwordx4 v[52:55], v26, s[50:51]
    global_load_dwordx4 v[56:59], v27, s[50:51]
    s_waitcnt vmcnt(4)
    ds_write_b128 v32, v[60:63]
    ds_write_b128 v33, v[64:67]
    ds_write_b128 v34, v[68:71]
    ds_write_b128 v35, v[72:75]
    s_waitcnt lgkmcnt(0)
    s_barrier
    ds_read_b64_tr_b16 a[144:145], v40 offset:0
    ds_read_b64_tr_b16 a[146:147], v40 offset:512
    ds_read_b64_tr_b16 a[148:149], v40 offset:8192
    ds_read_b64_tr_b16 a[150:151], v40 offset:8704
    ds_read_b64_tr_b16 v[68:69], v41 offset:0
    ds_read_b64_tr_b16 v[70:71], v41 offset:512
    ds_read_b64_tr_b16 v[72:73], v41 offset:8192
    ds_read_b64_tr_b16 v[74:75], v41 offset:8704
    s_waitcnt lgkmcnt(0)
    ds_write_b128 v11, v[68:71] offset:18432
    ds_write_b128 v11, v[72:75] offset:19456
    s_waitcnt lgkmcnt(0)
    s_barrier
    s_mul_i32 s12, s11, 163840
    s_add_u32 s12, s12, 0
    s_add_u32 s50, s46, s12
    s_addc_u32 s51, s47, 0
    global_load_dwordx4 v[60:63], v28, s[50:51]
    global_load_dwordx4 v[64:67], v29, s[50:51]
    global_load_dwordx4 v[68:71], v30, s[50:51]
    global_load_dwordx4 v[72:75], v31, s[50:51]
    s_waitcnt vmcnt(4)
    ds_write_b128 v32, v[44:47]
    ds_write_b128 v33, v[48:51]
    ds_write_b128 v34, v[52:55]
    ds_write_b128 v35, v[56:59]
    s_waitcnt lgkmcnt(0)
    s_barrier
    ds_read_b64_tr_b16 v[44:45], v40 offset:0
    ds_read_b64_tr_b16 v[46:47], v40 offset:512
    ds_read_b64_tr_b16 v[48:49], v40 offset:8192
    ds_read_b64_tr_b16 v[50:51], v40 offset:8704
    ds_read_b64_tr_b16 v[52:53], v41 offset:0
    ds_read_b64_tr_b16 v[54:55], v41 offset:512
    ds_read_b64_tr_b16 v[56:57], v41 offset:8192
    ds_read_b64_tr_b16 v[58:59], v41 offset:8704
    s_waitcnt lgkmcnt(0)
    v_add_u32 v38, 12288, v2
    global_store_dwordx4 v38, v[44:47], s[48:49]
    global_store_dwordx4 v38, v[48:51], s[48:49] offset:1024
    v_add_u32 v38, 14336, v2
    global_store_dwordx4 v38, v[52:55], s[48:49]
    global_store_dwordx4 v38, v[56:59], s[48:49] offset:1024
    s_waitcnt vmcnt(0)
    s_waitcnt lgkmcnt(0)
    s_barrier
    s_mul_i32 s12, s11, 163840
    s_add_u32 s12, s12, 81920
    s_add_u32 s50, s46, s12
    s_addc_u32 s51, s47, 0
    global_load_dwordx4 v[44:47], v28, s[50:51]
    global_load_dwordx4 v[48:51], v29, s[50:51]
    global_load_dwordx4 v[52:55], v30, s[50:51]
    global_load_dwordx4 v[56:59], v31, s[50:51]
    s_waitcnt vmcnt(4)
    ds_write_b128 v32, v[60:63]
    ds_write_b128 v33, v[64:67]
    ds_write_b128 v34, v[68:71]
    ds_write_b128 v35, v[72:75]
    s_waitcnt lgkmcnt(0)
    s_barrier
    ds_read_b64_tr_b16 a[152:153], v42 offset:0
    ds_read_b64_tr_b16 a[154:155], v42 offset:512
    ds_read_b64_tr_b16 a[156:157], v42 offset:8192
    ds_read_b64_tr_b16 a[158:159], v42 offset:8704
    ds_read_b64_tr_b16 v[68:69], v43 offset:0
    ds_read_b64_tr_b16 v[70:71], v43 offset:512
    ds_read_b64_tr_b16 v[72:73], v43 offset:8192
    ds_read_b64_tr_b16 v[74:75], v43 offset:8704
    s_waitcnt lgkmcnt(0)
    ds_write_b128 v11, v[68:71] offset:22528
    ds_write_b128 v11, v[72:75] offset:23552
    s_waitcnt lgkmcnt(0)
    s_barrier
    s_mul_i32 s12, s11, 163840
    s_add_u32 s12, s12, 256
    s_add_u32 s50, s46, s12
    s_addc_u32 s51, s47, 0
    global_load_dwordx4 v[60:63], v28, s[50:51]
    global_load_dwordx4 v[64:67], v29, s[50:51]
    global_load_dwordx4 v[68:71], v30, s[50:51]
    global_load_dwordx4 v[72:75], v31, s[50:51]
    s_waitcnt vmcnt(4)
    ds_write_b128 v32, v[44:47]
    ds_write_b128 v33, v[48:51]
    ds_write_b128 v34, v[52:55]
    ds_write_b128 v35, v[56:59]
    s_waitcnt lgkmcnt(0)
    s_barrier
    ds_read_b64_tr_b16 a[160:161], v42 offset:0
    ds_read_b64_tr_b16 a[162:163], v42 offset:512
    ds_read_b64_tr_b16 a[164:165], v42 offset:8192
    ds_read_b64_tr_b16 a[166:167], v42 offset:8704
    ds_read_b64_tr_b16 a[168:169], v43 offset:0
    ds_read_b64_tr_b16 a[170:171], v43 offset:512
    ds_read_b64_tr_b16 a[172:173], v43 offset:8192
    ds_read_b64_tr_b16 a[174:175], v43 offset:8704
    s_waitcnt lgkmcnt(0)
    s_waitcnt lgkmcnt(0)
    s_barrier
    s_mul_i32 s12, s11, 163840
    s_add_u32 s12, s12, 82176
    s_add_u32 s50, s46, s12
    s_addc_u32 s51, s47, 0
    global_load_dwordx4 v[44:47], v28, s[50:51]
    global_load_dwordx4 v[48:51], v29, s[50:51]
    global_load_dwordx4 v[52:55], v30, s[50:51]
    global_load_dwordx4 v[56:59], v31, s[50:51]
    s_waitcnt vmcnt(4)
    ds_write_b128 v32, v[60:63]
    ds_write_b128 v33, v[64:67]
    ds_write_b128 v34, v[68:71]
    ds_write_b128 v35, v[72:75]
    s_waitcnt lgkmcnt(0)
    s_barrier
    ds_read_b64_tr_b16 a[176:177], v42 offset:0
    ds_read_b64_tr_b16 a[178:179], v42 offset:512
    ds_read_b64_tr_b16 a[180:181], v42 offset:8192
    ds_read_b64_tr_b16 a[182:183], v42 offset:8704
    ds_read_b64_tr_b16 a[184:185], v43 offset:0
    ds_read_b64_tr_b16 a[186:187], v43 offset:512
    ds_read_b64_tr_b16 a[188:189], v43 offset:8192
    ds_read_b64_tr_b16 a[190:191], v43 offset:8704
    s_waitcnt lgkmcnt(0)
    s_waitcnt lgkmcnt(0)
    s_barrier
    s_mul_i32 s12, s11, 163840
    s_add_u32 s12, s12, 512
    s_add_u32 s50, s46, s12
    s_addc_u32 s51, s47, 0
    global_load_dwordx4 v[60:63], v28, s[50:51]
    global_load_dwordx4 v[64:67], v29, s[50:51]
    global_load_dwordx4 v[68:71], v30, s[50:51]
    global_load_dwordx4 v[72:75], v31, s[50:51]
    s_waitcnt vmcnt(4)
    ds_write_b128 v32, v[44:47]
    ds_write_b128 v33, v[48:51]
    ds_write_b128 v34, v[52:55]
    ds_write_b128 v35, v[56:59]
    s_waitcnt lgkmcnt(0)
    s_barrier
    ds_read_b64_tr_b16 v[44:45], v42 offset:0
    ds_read_b64_tr_b16 v[46:47], v42 offset:512
    ds_read_b64_tr_b16 v[48:49], v42 offset:8192
    ds_read_b64_tr_b16 v[50:51], v42 offset:8704
    ds_read_b64_tr_b16 a[192:193], v43 offset:0
    ds_read_b64_tr_b16 a[194:195], v43 offset:512
    ds_read_b64_tr_b16 a[196:197], v43 offset:8192
    ds_read_b64_tr_b16 a[198:199], v43 offset:8704
    s_waitcnt lgkmcnt(0)
    ds_write_b128 v11, v[44:47] offset:24576
    ds_write_b128 v11, v[48:51] offset:25600
    s_waitcnt lgkmcnt(0)
    s_barrier
    s_mul_i32 s12, s11, 163840
    s_add_u32 s12, s12, 82432
    s_add_u32 s50, s46, s12
    s_addc_u32 s51, s47, 0
    global_load_dwordx4 v[44:47], v28, s[50:51]
    global_load_dwordx4 v[48:51], v29, s[50:51]
    global_load_dwordx4 v[52:55], v30, s[50:51]
    global_load_dwordx4 v[56:59], v31, s[50:51]
    s_waitcnt vmcnt(4)
    ds_write_b128 v32, v[60:63]
    ds_write_b128 v33, v[64:67]
    ds_write_b128 v34, v[68:71]
    ds_write_b128 v35, v[72:75]
    s_waitcnt lgkmcnt(0)
    s_barrier
    ds_read_b64_tr_b16 v[60:61], v42 offset:0
    ds_read_b64_tr_b16 v[62:63], v42 offset:512
    ds_read_b64_tr_b16 v[64:65], v42 offset:8192
    ds_read_b64_tr_b16 v[66:67], v42 offset:8704
    ds_read_b64_tr_b16 a[208:209], v43 offset:0
    ds_read_b64_tr_b16 a[210:211], v43 offset:512
    ds_read_b64_tr_b16 a[212:213], v43 offset:8192
    ds_read_b64_tr_b16 a[214:215], v43 offset:8704
    s_waitcnt lgkmcnt(0)
    ds_write_b128 v11, v[60:63] offset:26624
    ds_write_b128 v11, v[64:67] offset:27648
    s_waitcnt lgkmcnt(0)
    s_barrier
    s_mul_i32 s12, s11, 163840
    s_add_u32 s12, s12, 768
    s_add_u32 s50, s46, s12
    s_addc_u32 s51, s47, 0
    global_load_dwordx4 v[60:63], v28, s[50:51]
    global_load_dwordx4 v[64:67], v29, s[50:51]
    global_load_dwordx4 v[68:71], v30, s[50:51]
    global_load_dwordx4 v[72:75], v31, s[50:51]
    s_waitcnt vmcnt(4)
    ds_write_b128 v32, v[44:47]
    ds_write_b128 v33, v[48:51]
    ds_write_b128 v34, v[52:55]
    ds_write_b128 v35, v[56:59]
    s_waitcnt lgkmcnt(0)
    s_barrier
    ds_read_b64_tr_b16 a[200:201], v42 offset:0
    ds_read_b64_tr_b16 a[202:203], v42 offset:512
    ds_read_b64_tr_b16 a[204:205], v42 offset:8192
    ds_read_b64_tr_b16 a[206:207], v42 offset:8704
    ds_read_b64_tr_b16 v[52:53], v43 offset:0
    ds_read_b64_tr_b16 v[54:55], v43 offset:512
    ds_read_b64_tr_b16 v[56:57], v43 offset:8192
    ds_read_b64_tr_b16 v[58:59], v43 offset:8704
    s_waitcnt lgkmcnt(0)
    ds_write_b128 v11, v[52:55] offset:28672
    ds_write_b128 v11, v[56:59] offset:29696
    s_waitcnt lgkmcnt(0)
    s_barrier
    s_mul_i32 s12, s11, 163840
    s_add_u32 s12, s12, 82688
    s_add_u32 s50, s46, s12
    s_addc_u32 s51, s47, 0
    global_load_dwordx4 v[44:47], v28, s[50:51]
    global_load_dwordx4 v[48:51], v29, s[50:51]
    global_load_dwordx4 v[52:55], v30, s[50:51]
    global_load_dwordx4 v[56:59], v31, s[50:51]
    s_waitcnt vmcnt(4)
    ds_write_b128 v32, v[60:63]
    ds_write_b128 v33, v[64:67]
    ds_write_b128 v34, v[68:71]
    ds_write_b128 v35, v[72:75]
    s_waitcnt lgkmcnt(0)
    s_barrier
    ds_read_b64_tr_b16 a[216:217], v42 offset:0
    ds_read_b64_tr_b16 a[218:219], v42 offset:512
    ds_read_b64_tr_b16 a[220:221], v42 offset:8192
    ds_read_b64_tr_b16 a[222:223], v42 offset:8704
    ds_read_b64_tr_b16 v[68:69], v43 offset:0
    ds_read_b64_tr_b16 v[70:71], v43 offset:512
    ds_read_b64_tr_b16 v[72:73], v43 offset:8192
    ds_read_b64_tr_b16 v[74:75], v43 offset:8704
    s_waitcnt lgkmcnt(0)
    ds_write_b128 v11, v[68:71] offset:30720
    ds_write_b128 v11, v[72:75] offset:31744
    s_waitcnt lgkmcnt(0)
    s_barrier
    s_mul_i32 s12, s11, 163840
    s_add_u32 s12, s12, 1024
    s_add_u32 s50, s46, s12
    s_addc_u32 s51, s47, 0
    global_load_dwordx4 v[60:63], v28, s[50:51]
    global_load_dwordx4 v[64:67], v29, s[50:51]
    global_load_dwordx4 v[68:71], v30, s[50:51]
    global_load_dwordx4 v[72:75], v31, s[50:51]
    s_waitcnt vmcnt(4)
    ds_write_b128 v32, v[44:47]
    ds_write_b128 v33, v[48:51]
    ds_write_b128 v34, v[52:55]
    ds_write_b128 v35, v[56:59]
    s_waitcnt lgkmcnt(0)
    s_barrier
    ds_read_b64_tr_b16 a[224:225], v42 offset:0
    ds_read_b64_tr_b16 a[226:227], v42 offset:512
    ds_read_b64_tr_b16 a[228:229], v42 offset:8192
    ds_read_b64_tr_b16 a[230:231], v42 offset:8704
    ds_read_b64_tr_b16 a[232:233], v43 offset:0
    ds_read_b64_tr_b16 a[234:235], v43 offset:512
    ds_read_b64_tr_b16 a[236:237], v43 offset:8192
    ds_read_b64_tr_b16 a[238:239], v43 offset:8704
    s_waitcnt lgkmcnt(0)
    s_waitcnt lgkmcnt(0)
    s_barrier
    s_mul_i32 s12, s11, 163840
    s_add_u32 s12, s12, 82944
    s_add_u32 s50, s46, s12
    s_addc_u32 s51, s47, 0
    global_load_dwordx4 v[44:47], v28, s[50:51]
    global_load_dwordx4 v[48:51], v29, s[50:51]
    global_load_dwordx4 v[52:55], v30, s[50:51]
    global_load_dwordx4 v[56:59], v31, s[50:51]
    s_waitcnt vmcnt(4)
    ds_write_b128 v32, v[60:63]
    ds_write_b128 v33, v[64:67]
    ds_write_b128 v34, v[68:71]
    ds_write_b128 v35, v[72:75]
    s_waitcnt lgkmcnt(0)
    s_barrier
    ds_read_b64_tr_b16 a[240:241], v42 offset:0
    ds_read_b64_tr_b16 a[242:243], v42 offset:512
    ds_read_b64_tr_b16 a[244:245], v42 offset:8192
    ds_read_b64_tr_b16 a[246:247], v42 offset:8704
    ds_read_b64_tr_b16 a[248:249], v43 offset:0
    ds_read_b64_tr_b16 a[250:251], v43 offset:512
    ds_read_b64_tr_b16 a[252:253], v43 offset:8192
    ds_read_b64_tr_b16 a[254:255], v43 offset:8704
    s_waitcnt lgkmcnt(0)
    s_waitcnt lgkmcnt(0)
    s_barrier
    s_lshl_b32 s12, s11, 8
    s_add_u32 s12, s12, 524288
    s_add_u32 s50, s40, s12
    s_addc_u32 s51, s41, 0
    global_load_dwordx4 v[60:63], v24, s[50:51]
    global_load_dwordx4 v[64:67], v25, s[50:51]
    global_load_dwordx4 v[68:71], v26, s[50:51]
    global_load_dwordx4 v[72:75], v27, s[50:51]
    s_waitcnt vmcnt(4)
    ds_write_b128 v32, v[44:47]
    ds_write_b128 v33, v[48:51]
    ds_write_b128 v34, v[52:55]
    ds_write_b128 v35, v[56:59]
    s_waitcnt lgkmcnt(0)
    s_barrier
    ds_read_b64_tr_b16 v[44:45], v42 offset:0
    ds_read_b64_tr_b16 v[46:47], v42 offset:512
    ds_read_b64_tr_b16 v[48:49], v42 offset:8192
    ds_read_b64_tr_b16 v[50:51], v42 offset:8704
    ds_read_b64_tr_b16 v[52:53], v43 offset:0
    ds_read_b64_tr_b16 v[54:55], v43 offset:512
    ds_read_b64_tr_b16 v[56:57], v43 offset:8192
    ds_read_b64_tr_b16 v[58:59], v43 offset:8704
    s_waitcnt lgkmcnt(0)
    ds_write_b128 v11, v[44:47] offset:32768
    ds_write_b128 v11, v[48:51] offset:33792
    v_add_u32 v38, 16384, v2
    global_store_dwordx4 v38, v[52:55], s[48:49]
    global_store_dwordx4 v38, v[56:59], s[48:49] offset:1024
    s_waitcnt vmcnt(0)
    s_waitcnt lgkmcnt(0)
    s_barrier
    s_waitcnt vmcnt(0)
    ds_write_b128 v32, v[60:63]
    ds_write_b128 v33, v[64:67]
    ds_write_b128 v34, v[68:71]
    ds_write_b128 v35, v[72:75]
    s_waitcnt lgkmcnt(0)
    s_barrier
    ds_read_b64_tr_b16 v[80:81], v40 offset:0
    ds_read_b64_tr_b16 v[82:83], v40 offset:512
    ds_read_b64_tr_b16 v[84:85], v40 offset:8192
    ds_read_b64_tr_b16 v[86:87], v40 offset:8704
    ds_read_b64_tr_b16 v[88:89], v41 offset:0
    ds_read_b64_tr_b16 v[90:91], v41 offset:512
    ds_read_b64_tr_b16 v[92:93], v41 offset:8192
    ds_read_b64_tr_b16 v[94:95], v41 offset:8704
    s_waitcnt lgkmcnt(0)
    s_waitcnt lgkmcnt(0)
    s_barrier
    s_cmp_lg_u32 s10, 0
    s_cbranch_scc1 Lwl_94
    s_mov_b64 exec, 1
    v_mov_b32 v48, 72
    v_mov_b32 v49, 1
    global_atomic_add v48, v49, s[6:7]
    s_mov_b64 exec, -1
Lwl_94:
    v_mov_b32 v11, v79
    s_add_u32 s22, s48, 0
    s_addc_u32 s23, s49, 0
    s_add_u32 s24, s48, 4096
    s_addc_u32 s25, s49, 0
    s_add_u32 s26, s48, 8192
    s_addc_u32 s27, s49, 0
    s_add_u32 s28, s48, 12288
    s_addc_u32 s29, s49, 0
    s_add_u32 s30, s48, 16384
    s_addc_u32 s31, s49, 0
    global_load_dwordx4 v[20:23], v2, s[22:23] offset:0
    global_load_dwordx4 v[24:27], v2, s[22:23] offset:1024
    global_load_dwordx4 v[36:39], v2, s[22:23] offset:2048
    global_load_dwordx4 v[40:43], v2, s[22:23] offset:3072
    global_load_dwordx4 v[64:67], v2, s[24:25] offset:0
    global_load_dwordx4 v[68:71], v2, s[24:25] offset:1024
    global_load_dwordx4 v[72:75], v2, s[24:25] offset:2048
    global_load_dwordx4 v[76:79], v2, s[24:25] offset:3072
    s_lshl_b32 s12, s11, 13
    s_lshl_b32 s13, s10, 11
    s_add_u32 s12, s12, s13
    s_add_u32 s58, s4, 0x1400000
    s_addc_u32 s59, s5, 0
    s_add_u32 s58, s58, s12
    s_addc_u32 s59, s59, 0
    s_add_u32 s60, s4, 0x2400000
    s_addc_u32 s61, s5, 0
    s_add_u32 s60, s60, s12
    s_addc_u32 s61, s61, 0
    s_lshl_b32 s12, s11, 13
    s_and_b32 s13, s10, 1
    s_lshl_b32 s13, s13, 12
    s_add_u32 s12, s12, s13
    s_add_u32 s12, s12, 524288
    s_cmp_lt_u32 s10, 2
    s_mov_b32 s13, 0x2400000
    s_cselect_b32 s13, 0x1400000, s13
    s_add_u32 s12, s12, s13
    s_add_u32 s56, s4, s12
    s_addc_u32 s57, s5, 0
    s_lshl_b32 s12, s11, 12
    s_lshl_b32 s13, s10, 10
    s_add_u32 s12, s12, s13
    s_add_u32 s62, s4, 0x3400000
    s_addc_u32 s63, s5, 0
    s_add_u32 s62, s62, s12
    s_addc_u32 s63, s63, 0
    s_lshl_b32 s12, s11, 11
    s_lshl_b32 s13, s10, 9
    s_add_u32 s12, s12, s13
    s_add_u32 s64, s4, 0x3c00000
    s_addc_u32 s65, s5, 0
    s_add_u32 s64, s64, s12
    s_addc_u32 s65, s65, 0
    s_lshl_b32 s12, s10, 10
    s_add_u32 s12, s12, 0
    s_add_u32 s66, s54, s12
    s_addc_u32 s67, s55, 0
    s_lshl_b32 s12, s10, 10
    s_add_u32 s12, s12, 4096
    s_add_u32 s68, s54, s12
    s_addc_u32 s69, s55, 0
    s_lshl_b32 s12, s10, 10
    s_add_u32 s12, s12, 8192
    s_add_u32 s70, s54, s12
    s_addc_u32 s71, s55, 0
    s_add_u32 s78, s54, 0
    s_addc_u32 s79, s55, 0
    s_lshl_b32 s12, s10, 10
    s_add_u32 s12, s12, 10240
    s_add_u32 s72, s54, s12
    s_addc_u32 s73, s55, 0
    s_lshl_b32 s12, s10, 10
    s_add_u32 s12, s12, 14336
    s_add_u32 s74, s54, s12
    s_addc_u32 s75, s55, 0
    s_lshl_b32 s12, s10, 10
    s_add_u32 s12, s12, 18432
    s_add_u32 s76, s54, s12
    s_addc_u32 s77, s55, 0
    s_add_u32 s80, s54, 10240
    s_addc_u32 s81, s55, 0
    s_add_u32 s82, s52, 0
    s_addc_u32 s83, s53, 0
    s_add_u32 s84, s52, 65536
    s_addc_u32 s85, s53, 0
    s_add_u32 s86, s52, 131072
    s_addc_u32 s87, s53, 0
    s_add_u32 s88, s52, 196608
    s_addc_u32 s89, s53, 0
    s_add_u32 s90, s52, 262144
    s_addc_u32 s91, s53, 0
    s_lshl_b32 s21, s10, 11
    s_add_u32 s21, s21, 10240
    s_waitcnt vmcnt(0) lgkmcnt(0)
    s_barrier
    s_cmp_lg_u32 s10, 0
    s_cbranch_scc1 Lcd_96
    s_mov_b64 exec, 1
    v_mov_b32 v0, 36
    s_mov_b32 s14, 4000000
Lcb_95:
    global_load_dword v1, v0, s[6:7] sc1
    s_waitcnt vmcnt(0)
    v_readfirstlane_b32 s12, v1
    s_sub_u32 s14, s14, 1
    s_cbranch_scc1 Lcd_96
    s_cmp_lt_u32 s12, 32
    s_cbranch_scc1 Lcb_95
Lcd_96:
    s_mov_b64 exec, -1
    s_barrier
    s_mov_b32 s18, 0
    s_mov_b32 s19, 8000000
    s_mov_b32 s20, 0x3e0293ee
    s_mov_b32 s98, 0
    s_mov_b32 s100, 0
    s_cmp_lt_u32 s100, s98
    s_cbranch_scc1 Lkr_97
Lkp_98:
    v_lshrrev_b32 v0, 2, v2
    s_mov_b64 exec, 0xffff
    global_load_dword v1, v0, s[6:7] offset:192 sc1
    s_waitcnt vmcnt(0)
    v_and_b32 v1, 0xffff, v1
    v_cmp_le_u32 vcc, 64, v1
    s_mov_b64 exec, -1
    s_nop 3
    s_or_b32 s99, vcc_lo, 0xffff0000
    s_not_b32 s99, s99
    s_ff1_i32_b32 s98, s99
    s_cmp_eq_u32 s98, -1
    s_cselect_b32 s98, 16, s98
    s_sub_u32 s19, s19, 1
    s_cbranch_scc1 Lend_1
    s_cmp_lt_u32 s100, s98
    s_cbranch_scc0 Lkp_98
Lkr_97:
    s_lshr_b32 s12, s11, 2
    s_lshl_b32 s12, s12, 7
    s_and_b32 s13, s11, 3
    s_lshl_b32 s13, s13, 2
    s_add_u32 s12, s12, s13
    s_add_u32 s101, s12, 0x7403000
    s_mov_b32 s96, -1
    s_mov_b32 s97, 0
    s_mov_b32 m0, s21
    s_nop 0
    global_load_lds_dwordx4 v2, s[58:59] sc1
    s_add_u32 m0, s21, 1024
    v_add_u32 v1, 1024, v2
    global_load_lds_dwordx4 v1, s[58:59] sc1
    s_add_u32 s58, s58, 262144
    s_addc_u32 s59, s59, 0
    v_mov_b32 v12, 0
    v_mov_b32 v56, 0
    v_mov_b32 v28, 0
    v_mov_b32 v13, 0
    v_mov_b32 v57, 0
    v_mov_b32 v29, 0
    v_mov_b32 v14, 0
    v_mov_b32 v58, 0
    v_mov_b32 v30, 0
    v_mov_b32 v15, 0
    v_mov_b32 v59, 0
    v_mov_b32 v31, 0
    v_mov_b32 v16, 0
    v_mov_b32 v60, 0
    v_mov_b32 v32, 0
    v_mov_b32 v17, 0
    v_mov_b32 v61, 0
    v_mov_b32 v33, 0
    v_mov_b32 v18, 0
    v_mov_b32 v62, 0
    v_mov_b32 v34, 0
    v_mov_b32 v19, 0
    v_mov_b32 v63, 0
    v_mov_b32 v35, 0
    s_lshl_b32 s13, s10, 7
    s_add_u32 s13, s13, 0
    s_add_u32 s12, s8, s13
    s_addc_u32 s13, s9, 0
    global_load_dwordx4 v[44:47], v11, s[12:13]
    s_lshl_b32 s13, s10, 7
    s_add_u32 s13, s13, 512
    s_add_u32 s12, s8, s13
    s_addc_u32 s13, s9, 0
    global_load_dwordx4 v[48:51], v11, s[12:13]
    s_lshl_b32 s13, s10, 7
    s_add_u32 s13, s13, 1024
    s_add_u32 s12, s8, s13
    s_addc_u32 s13, s9, 0
    s_cmp_ge_u32 s10, 2
    s_cbranch_scc1 Lsk_99
    global_load_dwordx4 v[52:55], v11, s[12:13]
Lsk_99:
    s_waitcnt vmcnt(0)
    s_branch LentA_102
LstepA_100:
    s_cmp_ge_u32 s10, 2
    s_cbranch_scc0 Lsk_104
    v_mov_b32 v52, 0
    v_mov_b32 v53, 0
    v_mov_b32 v54, 0
    v_mov_b32 v55, 0
Lsk_104:
Lgpoll_103:
    global_load_dwordx4 v[44:47], v3, s[66:67] sc1
    global_load_dwordx4 v[48:51], v3, s[68:69] sc1
    s_cmp_ge_u32 s10, 2
    s_cbranch_scc1 Lsk_105
    global_load_dwordx4 v[52:55], v3, s[70:71] sc1
Lsk_105:
    s_waitcnt vmcnt(0)
    v_max3_u32 v0, v44, v45, v46
    v_max3_u32 v1, v47, v48, v49
    v_max3_u32 v0, v0, v50, v51
    v_max3_u32 v1, v1, v52, v53
    v_max3_u32 v0, v0, v54, v55
    v_max_u32 v0, v0, v1
    v_cmp_eq_u32 vcc, -1, v0
    s_sub_u32 s19, s19, 1
    s_cbranch_scc1 Lend_1
    s_cbranch_vccnz Lgpoll_103
LentA_102:
    s_lshl_b32 s13, s10, 10
    v_add_u32 v1, s13, v2
    ds_write_b128 v1, v[44:47] offset:0
    ds_write_b128 v1, v[48:51] offset:4096
    s_cmp_ge_u32 s10, 2
    s_cbranch_scc1 Lsk_106
    ds_write_b128 v1, v[52:55] offset:8192
Lsk_106:
    v_add_u32 v11, s17, v2
    s_waitcnt lgkmcnt(0)
    s_barrier
    ds_read_b128 v[44:47], v2 offset:0
    ds_read_b128 v[48:51], v2 offset:1024
    ds_read_b128 v[52:55], v2 offset:2048
    s_waitcnt lgkmcnt(2)
    v_smfmac_f32_16x16x64_bf16 v[56:59], v[44:47], v[64:71], v4
    ds_read_b128 v[64:67], v11 offset:0
    ds_read_b128 v[68:71], v11 offset:1024
    v_smfmac_f32_16x16x64_bf16 v[60:63], v[44:47], v[72:79], v4
    ds_read_b128 v[72:75], v11 offset:2048
    ds_read_b128 v[76:79], v11 offset:3072
    v_smfmac_f32_16x16x64_bf16 v[12:15], v[44:47], v[20:27], v4
    v_smfmac_f32_16x16x64_bf16 v[16:19], v[44:47], v[36:43], v4
    global_load_dwordx4 v[20:23], v2, s[26:27] offset:0
    v_smfmac_f32_16x16x64_bf16 v[28:31], v[44:47], a[56:63], v4
    v_smfmac_f32_16x16x64_bf16 v[32:35], v[44:47], a[64:71], v4
    global_load_dwordx4 v[24:27], v2, s[26:27] offset:1024
    ds_read_b128 v[44:47], v2 offset:3072
    s_waitcnt lgkmcnt(6)
    v_smfmac_f32_16x16x64_bf16 v[12:15], v[48:51], v[80:87], v4
    v_smfmac_f32_16x16x64_bf16 v[16:19], v[48:51], v[88:95], v4
    global_load_dwordx4 v[36:39], v2, s[26:27] offset:2048
    v_smfmac_f32_16x16x64_bf16 v[56:59], v[48:51], v[200:207], v4
    v_smfmac_f32_16x16x64_bf16 v[60:63], v[48:51], v[208:215], v4
    global_load_dwordx4 v[40:43], v2, s[26:27] offset:3072
    s_waitcnt lgkmcnt(3)
    v_smfmac_f32_16x16x64_bf16 v[28:31], v[48:51], v[64:71], v4
    ds_read_b128 v[64:67], v11 offset:4096
    ds_read_b128 v[68:71], v11 offset:5120
    v_smfmac_f32_16x16x64_bf16 v[32:35], v[48:51], a[72:79], v4
    ds_read_b128 v[48:51], v2 offset:4096
    v_smfmac_f32_16x16x64_bf16 v[12:15], v[52:55], v[96:103], v4
    v_smfmac_f32_16x16x64_bf16 v[16:19], v[52:55], v[104:111], v4
    s_waitcnt lgkmcnt(4)
    v_smfmac_f32_16x16x64_bf16 v[56:59], v[52:55], v[72:79], v4
    ds_read_b128 v[72:75], v11 offset:6144
    ds_read_b128 v[76:79], v11 offset:7168
    v_smfmac_f32_16x16x64_bf16 v[60:63], v[52:55], v[216:223], v4
    v_smfmac_f32_16x16x64_bf16 v[28:31], v[52:55], a[80:87], v4
    v_smfmac_f32_16x16x64_bf16 v[32:35], v[52:55], a[88:95], v4
    ds_read_b128 v[52:55], v2 offset:5120
    s_waitcnt lgkmcnt(6)
    v_smfmac_f32_16x16x64_bf16 v[12:15], v[44:47], v[112:119], v4
    s_waitcnt lgkmcnt(4)
    v_smfmac_f32_16x16x64_bf16 v[16:19], v[44:47], v[64:71], v4
    ds_read_b128 v[64:67], v11 offset:8192
    ds_read_b128 v[68:71], v11 offset:9216
    v_smfmac_f32_16x16x64_bf16 v[56:59], v[44:47], v[224:231], v4
    v_smfmac_f32_16x16x64_bf16 v[60:63], v[44:47], v[232:239], v4
    v_smfmac_f32_16x16x64_bf16 v[28:31], v[44:47], a[96:103], v4
    s_waitcnt lgkmcnt(3)
    v_smfmac_f32_16x16x64_bf16 v[32:35], v[44:47], v[72:79], v4
    ds_read_b128 v[72:75], v11 offset:10240
    ds_read_b128 v[76:79], v11 offset:11264
    ds_read_b128 v[44:47], v2 offset:6144
    v_smfmac_f32_16x16x64_bf16 v[12:15], v[48:51], v[120:127], v4
    v_smfmac_f32_16x16x64_bf16 v[16:19], v[48:51], v[128:135], v4
    v_smfmac_f32_16x16x64_bf16 v[56:59], v[48:51], v[240:247], v4
    s_waitcnt lgkmcnt(3)
    v_smfmac_f32_16x16x64_bf16 v[60:63], v[48:51], v[64:71], v4
    ds_read_b128 v[64:67], v11 offset:12288
    ds_read_b128 v[68:71], v11 offset:13312
    v_smfmac_f32_16x16x64_bf16 v[28:31], v[48:51], a[104:111], v4
    v_smfmac_f32_16x16x64_bf16 v[32:35], v[48:51], a[112:119], v4
    ds_read_b128 v[48:51], v2 offset:7168
    s_waitcnt lgkmcnt(4)
    v_smfmac_f32_16x16x64_bf16 v[12:15], v[52:55], v[72:79], v4
    ds_read_b128 v[72:75], v11 offset:16384
    ds_read_b128 v[76:79], v11 offset:17408
    v_smfmac_f32_16x16x64_bf16 v[16:19], v[52:55], v[136:143], v4
    v_smfmac_f32_16x16x64_bf16 v[56:59], v[52:55], v[248:255], v4
    v_smfmac_f32_16x16x64_bf16 v[60:63], v[52:55], a[0:7], v4
    s_waitcnt vmcnt(2)
    v_smfmac_f32_16x16x64_bf16 v[28:31], v[52:55], v[20:27], v4
    s_waitcnt vmcnt(0)
    v_smfmac_f32_16x16x64_bf16 v[32:35], v[52:55], v[36:43], v4
    global_load_dwordx4 v[20:23], v2, s[28:29] offset:0
    ds_read_b128 v[52:55], v2 offset:8192
    s_waitcnt lgkmcnt(6)
    v_smfmac_f32_16x16x64_bf16 v[12:15], v[44:47], v[144:151], v4
    v_smfmac_f32_16x16x64_bf16 v[16:19], v[44:47], v[152:159], v4
    global_load_dwordx4 v[24:27], v2, s[28:29] offset:1024
    v_smfmac_f32_16x16x64_bf16 v[56:59], v[44:47], a[8:15], v4
    v_smfmac_f32_16x16x64_bf16 v[60:63], v[44:47], a[16:23], v4
    global_load_dwordx4 v[36:39], v2, s[28:29] offset:2048
    s_waitcnt lgkmcnt(4)
    v_smfmac_f32_16x16x64_bf16 v[28:31], v[44:47], v[64:71], v4
    ds_read_b128 v[64:67], v11 offset:14336
    ds_read_b128 v[68:71], v11 offset:15360
    v_smfmac_f32_16x16x64_bf16 v[32:35], v[44:47], a[120:127], v4
    global_load_dwordx4 v[40:43], v2, s[28:29] offset:3072
    ds_read_b128 v[44:47], v2 offset:9216
    s_waitcnt lgkmcnt(6)
    v_smfmac_f32_16x16x64_bf16 v[12:15], v[48:51], v[160:167], v4
    s_waitcnt lgkmcnt(4)
    v_smfmac_f32_16x16x64_bf16 v[16:19], v[48:51], v[72:79], v4
    ds_read_b128 v[72:75], v11 offset:18432
    ds_read_b128 v[76:79], v11 offset:19456
    s_waitcnt lgkmcnt(3)
    v_smfmac_f32_16x16x64_bf16 v[56:59], v[48:51], v[64:71], v4
    ds_read_b128 v[64:67], v11 offset:20480
    ds_read_b128 v[68:71], v11 offset:21504
    v_smfmac_f32_16x16x64_bf16 v[60:63], v[48:51], a[24:31], v4
    v_smfmac_f32_16x16x64_bf16 v[28:31], v[48:51], a[128:135], v4
    v_smfmac_f32_16x16x64_bf16 v[32:35], v[48:51], a[136:143], v4
    v_smfmac_f32_16x16x64_bf16 v[12:15], v[52:55], v[168:175], v4
    v_smfmac_f32_16x16x64_bf16 v[16:19], v[52:55], v[176:183], v4
    v_smfmac_f32_16x16x64_bf16 v[56:59], v[52:55], a[32:39], v4
    v_smfmac_f32_16x16x64_bf16 v[60:63], v[52:55], a[40:47], v4
    v_smfmac_f32_16x16x64_bf16 v[28:31], v[52:55], a[144:151], v4
    s_waitcnt lgkmcnt(2)
    v_smfmac_f32_16x16x64_bf16 v[32:35], v[52:55], v[72:79], v4
    v_smfmac_f32_16x16x64_bf16 v[12:15], v[44:47], v[184:191], v4
    v_smfmac_f32_16x16x64_bf16 v[16:19], v[44:47], v[192:199], v4
    v_smfmac_f32_16x16x64_bf16 v[56:59], v[44:47], a[48:55], v4
    s_waitcnt lgkmcnt(0)
    v_smfmac_f32_16x16x64_bf16 v[60:63], v[44:47], v[64:71], v4
    s_waitcnt vmcnt(2)
    v_smfmac_f32_16x16x64_bf16 v[28:31], v[44:47], v[20:27], v4
    s_waitcnt vmcnt(0)
    v_smfmac_f32_16x16x64_bf16 v[32:35], v[44:47], v[36:43], v4
    global_load_dwordx4 v[36:39], v2, s[60:61] sc1
    s_nop 4
    v_permlane32_swap_b32 v12, v16
    v_permlane32_swap_b32 v13, v17
    v_permlane32_swap_b32 v14, v18
    v_permlane32_swap_b32 v15, v19
    v_pk_add_f32 v[12:13], v[12:13], v[16:17]
    v_pk_add_f32 v[14:15], v[14:15], v[18:19]
    v_cvt_pk_bf16_f32 v12, v12, v13
    v_cvt_pk_bf16_f32 v13, v14, v15
    ds_write_b64 v8, v[12:13] offset:18432
    global_load_dwordx4 v[40:43], v2, s[60:61] offset:1024 sc1
    v_permlane32_swap_b32 v56, v60
    v_permlane32_swap_b32 v57, v61
    v_permlane32_swap_b32 v58, v62
    v_permlane32_swap_b32 v59, v63
    v_pk_add_f32 v[56:57], v[56:57], v[60:61]
    v_pk_add_f32 v[58:59], v[58:59], v[62:63]
    v_cvt_pk_bf16_f32 v56, v56, v57
    v_cvt_pk_bf16_f32 v57, v58, v59
    ds_write_b64 v8, v[56:57] offset:20480
    ds_read_b128 v[20:23], v2 offset:10240
    ds_read_b128 v[24:27], v2 offset:14336
    s_and_b32 s99, s18, 3
    s_cmp_lg_u32 s99, 2
    s_cbranch_scc1 Lkv_107
    s_cmp_ge_u32 s18, 62
    s_cbranch_scc1 Lkv_107
    s_add_u32 s100, s18, 2
    s_lshr_b32 s100, s100, 2
    s_cmp_lt_u32 s100, s98
    s_cbranch_scc1 Lkr_108
Lkp_109:
    v_lshrrev_b32 v0, 2, v2
    s_mov_b64 exec, 0xffff
    global_load_dword v1, v0, s[6:7] offset:192 sc1
    s_waitcnt vmcnt(0)
    v_and_b32 v1, 0xffff, v1
    v_cmp_le_u32 vcc, 64, v1
    s_mov_b64 exec, -1
    s_nop 3
    s_or_b32 s99, vcc_lo, 0xffff0000
    s_not_b32 s99, s99
    s_ff1_i32_b32 s98, s99
    s_cmp_eq_u32 s98, -1
    s_cselect_b32 s98, 16, s98
    s_sub_u32 s19, s19, 1
    s_cbranch_scc1 Lend_1
    s_cmp_lt_u32 s100, s98
    s_cbranch_scc0 Lkp_109
Lkr_108:
Lkv_107:
    v_lshlrev_b32 v1, 2, v2
    s_mov_b32 m0, 22528
    s_nop 0
    s_waitcnt lgkmcnt(0)
    s_barrier
    ds_read_b64_tr_b16 v[64:65], v9 offset:18432
    ds_read_b64_tr_b16 v[66:67], v9 offset:18496
    ds_read_b64_tr_b16 v[12:13], v9 offset:20480
    ds_read_b64_tr_b16 v[14:15], v9 offset:20544
    ds_read_b64_tr_b16 v[68:69], v9 offset:18944
    ds_read_b64_tr_b16 v[70:71], v9 offset:19008
    ds_read_b64_tr_b16 v[16:17], v9 offset:20992
    ds_read_b64_tr_b16 v[18:19], v9 offset:21056
    ds_read_b128 v[72:75], v2 offset:11264
    ds_read_b128 v[76:79], v2 offset:15360
    s_waitcnt lgkmcnt(8)
    s_waitcnt lgkmcnt(6)
    v_mfma_f32_16x16x32_bf16 v[44:47], v[12:15], v[64:67], 0
    v_mfma_f32_16x16x32_bf16 v[48:51], v[20:23], v[64:67], 0
    ds_read_b128 v[20:23], v2 offset:12288
    v_mfma_f32_16x16x32_bf16 v[52:55], v[24:27], v[64:67], 0
    ds_read_b128 v[24:27], v2 offset:16384
    ds_read_b64_tr_b16 v[64:65], v9 offset:19456
    ds_read_b64_tr_b16 v[66:67], v9 offset:19520
    ds_read_b64_tr_b16 v[56:57], v9 offset:21504
    ds_read_b64_tr_b16 v[58:59], v9 offset:21568
    s_waitcnt lgkmcnt(10)
    s_waitcnt lgkmcnt(8)
    v_mfma_f32_16x16x32_bf16 v[44:47], v[16:19], v[68:71], v[44:47]
    s_waitcnt lgkmcnt(7)
    v_mfma_f32_16x16x32_bf16 v[48:51], v[72:75], v[68:71], v[48:51]
    ds_read_b128 v[72:75], v2 offset:13312
    s_waitcnt lgkmcnt(7)
    v_mfma_f32_16x16x32_bf16 v[52:55], v[76:79], v[68:71], v[52:55]
    ds_read_b128 v[76:79], v2 offset:17408
    ds_read_b64_tr_b16 v[68:69], v9 offset:19968
    ds_read_b64_tr_b16 v[70:71], v9 offset:20032
    ds_read_b64_tr_b16 v[60:61], v9 offset:22016
    ds_read_b64_tr_b16 v[62:63], v9 offset:22080
    s_waitcnt lgkmcnt(8)
    s_waitcnt lgkmcnt(6)
    v_mfma_f32_16x16x32_bf16 v[44:47], v[56:59], v[64:67], v[44:47]
    v_mfma_f32_16x16x32_bf16 v[48:51], v[20:23], v[64:67], v[48:51]
    v_mfma_f32_16x16x32_bf16 v[52:55], v[24:27], v[64:67], v[52:55]
    s_waitcnt lgkmcnt(2)
    s_waitcnt lgkmcnt(0)
    v_mfma_f32_16x16x32_bf16 v[44:47], v[60:63], v[68:71], v[44:47]
    v_mfma_f32_16x16x32_bf16 v[48:51], v[72:75], v[68:71], v[48:51]
    v_mfma_f32_16x16x32_bf16 v[52:55], v[76:79], v[68:71], v[52:55]
    v_permlane32_swap_b32 v28, v32
    v_permlane32_swap_b32 v29, v33
    v_permlane32_swap_b32 v30, v34
    v_permlane32_swap_b32 v31, v35
    v_pk_add_f32 v[28:29], v[28:29], v[32:33]
    v_pk_add_f32 v[30:31], v[30:31], v[34:35]
    v_cvt_pk_bf16_f32 v28, v28, v29
    v_cvt_pk_bf16_f32 v29, v30, v31
    v_lshrrev_b32 v1, 1, v2
    global_store_dwordx2 v1, v[28:29], s[64:65] sc1
    s_cmp_lg_u32 s10, 0
    s_cbranch_scc1 Lkmn_111
    global_store_dwordx4 v2, v[12:15], s[62:63] sc1
    s_branch Lkm_110
Lkmn_111:
    s_cmp_lg_u32 s10, 1
    s_cbranch_scc1 Lkmn_112
    global_store_dwordx4 v2, v[16:19], s[62:63] sc1
    s_branch Lkm_110
Lkmn_112:
    s_cmp_lg_u32 s10, 2
    s_cbranch_scc1 Lkmn_113
    global_store_dwordx4 v2, v[56:59], s[62:63] sc1
    s_branch Lkm_110
Lkmn_113:
    global_store_dwordx4 v2, v[60:63], s[62:63] sc1
Lkm_110:
    s_cmp_eq_u32 s18, 63
    s_cbranch_scc1 Lfin_91
    s_barrier
    s_mov_b32 m0, s21
    s_nop 0
    global_load_lds_dwordx4 v2, s[58:59] sc1
    s_add_u32 m0, s21, 1024
    v_add_u32 v1, 1024, v2
    global_load_lds_dwordx4 v1, s[58:59] sc1
    s_add_u32 s58, s58, 262144
    s_addc_u32 s59, s59, 0
    v_max3_f32 v0, v44, v45, v46
    v_max3_f32 v1, v47, v48, v49
    v_max3_f32 v0, v0, v50, v51
    v_max3_f32 v1, v1, v52, v53
    v_max3_f32 v0, v0, v54, v55
    v_max_f32 v0, v0, v1
    v_mov_b32 v1, v0
    s_nop 1
    v_permlane16_swap_b32 v0, v1
    v_max_f32 v0, v0, v1
    v_mov_b32 v1, v0
    s_nop 1
    v_permlane32_swap_b32 v0, v1
    v_max_f32 v0, v0, v1
    v_mul_f32 v0, s20, v0
    v_fma_f32 v48, v48, s20, -v0
    v_fma_f32 v49, v49, s20, -v0
    v_fma_f32 v50, v50, s20, -v0
    v_fma_f32 v51, v51, s20, -v0
    v_fma_f32 v52, v52, s20, -v0
    v_fma_f32 v53, v53, s20, -v0
    v_fma_f32 v54, v54, s20, -v0
    v_fma_f32 v55, v55, s20, -v0
    v_fma_f32 v44, v44, s20, -v0
    v_fma_f32 v45, v45, s20, -v0
    v_fma_f32 v46, v46, s20, -v0
    v_fma_f32 v47, v47, s20, -v0
    v_exp_f32 v48, v48
    v_exp_f32 v49, v49
    v_exp_f32 v50, v50
    v_exp_f32 v51, v51
    v_exp_f32 v52, v52
    v_exp_f32 v53, v53
    v_exp_f32 v54, v54
    v_exp_f32 v55, v55
    v_cvt_pk_bf16_f32 v12, v48, v49
    v_cvt_pk_bf16_f32 v13, v50, v51
    v_cvt_pk_bf16_f32 v14, v52, v53
    v_cvt_pk_bf16_f32 v15, v54, v55
    v_mov_b32 v56, 0x3f803f80
    v_mov_b32 v57, 0x3f803f80
    v_mov_b32 v58, 0x3f803f80
    v_mov_b32 v59, 0x3f803f80
    v_exp_f32 v44, v44
    v_exp_f32 v45, v45
    v_exp_f32 v46, v46
    v_exp_f32 v47, v47
    s_waitcnt vmcnt(4)
    s_cmp_lg_u32 s10, 3
    s_cbranch_scc1 Lpg_115
    s_mov_b64 exec, 1
    v_mov_b32 v0, s101
    v_mov_b32 v1, s18
    global_store_dword v0, v1, s[4:5] sc1
    s_mov_b64 exec, -1
Lpg_115:
    v_mfma_f32_16x16x32_bf16 v[72:75], v[56:59], v[12:15], 0
    v_cvt_pk_bf16_f32 v0, v44, v45
    v_cvt_pk_bf16_f32 v1, v46, v47
    v_mfma_f32_16x16x32_bf16 v[20:23], v[36:39], v[12:15], 0
    v_cndmask_b32_e64 v16, 0, v0, s[96:97]
    v_cndmask_b32_e64 v17, 0, v1, s[96:97]
    v_mfma_f32_16x16x32_bf16 v[24:27], v[40:43], v[12:15], 0
    v_cndmask_b32_e64 v18, v0, 0, s[96:97]
    v_cndmask_b32_e64 v19, v1, 0, s[96:97]
    ds_read_b128 v[64:67], v11 offset:22528
    ds_read_b128 v[68:71], v11 offset:23552
    s_add_u32 s60, s60, 262144
    s_addc_u32 s61, s61, 0
    s_add_u32 s56, s56, 262144
    s_addc_u32 s57, s57, 0
    s_add_u32 s62, s62, 131072
    s_addc_u32 s63, s63, 0
    s_add_u32 s64, s64, 65536
    s_addc_u32 s65, s65, 0
    s_nop 1
    v_mfma_f32_16x16x16_bf16 v[72:75], v[56:57], v[16:17], v[72:75]
    v_mfma_f32_16x16x16_bf16 v[20:23], v[28:29], v[16:17], v[20:23]
    v_mfma_f32_16x16x16_bf16 v[24:27], v[28:29], v[18:19], v[24:27]
    v_and_b32 v49, 0x70, v2
    v_lshrrev_b32 v48, 8, v2
    v_lshl_add_u32 v48, v48, 7, v49
    s_nop 2
    v_rcp_f32 v0, v72
    s_nop 1
    v_pk_mul_f32 v[20:21], v[20:21], v[0:1] op_sel_hi:[1,0]
    v_pk_mul_f32 v[22:23], v[22:23], v[0:1] op_sel_hi:[1,0]
    v_pk_mul_f32 v[24:25], v[24:25], v[0:1] op_sel_hi:[1,0]
    v_pk_mul_f32 v[26:27], v[26:27], v[0:1] op_sel_hi:[1,0]
    v_cvt_pk_bf16_f32 v44, v20, v21
    v_cvt_pk_bf16_f32 v45, v22, v23
    v_cvt_pk_bf16_f32 v46, v24, v25
    v_cvt_pk_bf16_f32 v47, v26, v27
    s_mov_b32 exec_lo, 0x00ff00ff
    s_mov_b32 exec_hi, 0x00ff00ff
    ds_write2_b32 v10, v44, v45 offset0:0 offset1:2
    ds_write2_b32 v10, v46, v47 offset0:64 offset1:66
    s_mov_b64 exec, -1
    global_load_dwordx4 v[72:75], v2, s[30:31] offset:0
    global_load_dwordx4 v[76:79], v2, s[30:31] offset:1024
    s_waitcnt lgkmcnt(0)
    s_barrier
    ds_read_b128 v[12:15], v48 offset:18432
    ds_read_b128 v[16:19], v48 offset:18944
    ds_read_b128 v[56:59], v48 offset:19456
    ds_read_b128 v[60:63], v48 offset:19968
    s_waitcnt lgkmcnt(3)
    v_mfma_f32_16x16x32_bf16 v[44:47], v[12:15], a[152:155], 0
    s_waitcnt lgkmcnt(2)
    v_mfma_f32_16x16x32_bf16 v[44:47], v[16:19], a[156:159], v[44:47]
    s_waitcnt lgkmcnt(1)
    v_mfma_f32_16x16x32_bf16 v[44:47], v[56:59], a[160:163], v[44:47]
    s_waitcnt lgkmcnt(0)
    v_mfma_f32_16x16x32_bf16 v[44:47], v[60:63], a[164:167], v[44:47]
    v_mfma_f32_16x16x32_bf16 v[48:51], v[12:15], v[64:67], 0
    v_mfma_f32_16x16x32_bf16 v[48:51], v[16:19], v[68:71], v[48:51]
    ds_read_b128 v[64:67], v11 offset:24576
    ds_read_b128 v[68:71], v11 offset:25600
    v_mfma_f32_16x16x32_bf16 v[48:51], v[56:59], a[168:171], v[48:51]
    s_mov_b32 exec_hi, 0
    v_cvt_pk_bf16_f32 v52, v44, v45
    v_cvt_pk_bf16_f32 v53, v46, v47
    s_mov_b32 exec_hi, -1
    v_mfma_f32_16x16x32_bf16 v[48:51], v[60:63], a[172:175], v[48:51]
    v_mfma_f32_16x16x32_bf16 v[44:47], v[12:15], a[176:179], 0
    v_mfma_f32_16x16x32_bf16 v[44:47], v[16:19], a[180:183], v[44:47]
    s_waitcnt lgkmcnt(0)
    v_mfma_f32_16x16x32_bf16 v[44:47], v[56:59], v[64:67], v[44:47]
    s_mov_b32 exec_lo, 0
    v_cvt_pk_bf16_f32 v52, v48, v49
    v_cvt_pk_bf16_f32 v53, v50, v51
    s_mov_b32 exec_lo, -1
    v_and_b32 v52, 0xfffffffe, v52
    global_store_dwordx2 v5, v[52:53], s[82:83]
    v_mfma_f32_16x16x32_bf16 v[44:47], v[60:63], v[68:71], v[44:47]
    global_load_dwordx4 v[20:23], v2, s[22:23] offset:0
    ds_read_b128 v[64:67], v11 offset:26624
    ds_read_b128 v[68:71], v11 offset:27648
    v_mfma_f32_16x16x32_bf16 v[48:51], v[12:15], a[184:187], 0
    v_mfma_f32_16x16x32_bf16 v[48:51], v[16:19], a[188:191], v[48:51]
    v_mfma_f32_16x16x32_bf16 v[48:51], v[56:59], a[192:195], v[48:51]
    s_mov_b32 exec_hi, 0
    v_cvt_pk_bf16_f32 v54, v44, v45
    v_cvt_pk_bf16_f32 v55, v46, v47
    s_mov_b32 exec_hi, -1
    v_mfma_f32_16x16x32_bf16 v[48:51], v[60:63], a[196:199], v[48:51]
    s_waitcnt lgkmcnt(0)
    v_mfma_f32_16x16x32_bf16 v[44:47], v[12:15], v[64:67], 0
    v_mfma_f32_16x16x32_bf16 v[44:47], v[16:19], v[68:71], v[44:47]
    ds_read_b128 v[64:67], v11 offset:28672
    ds_read_b128 v[68:71], v11 offset:29696
    v_mfma_f32_16x16x32_bf16 v[44:47], v[56:59], a[200:203], v[44:47]
    s_mov_b32 exec_lo, 0
    v_cvt_pk_bf16_f32 v54, v48, v49
    v_cvt_pk_bf16_f32 v55, v50, v51
    s_mov_b32 exec_lo, -1
    v_and_b32 v54, 0xfffffffe, v54
    global_store_dwordx2 v5, v[54:55], s[84:85]
    v_mfma_f32_16x16x32_bf16 v[44:47], v[60:63], a[204:207], v[44:47]
    global_load_dwordx4 v[24:27], v2, s[22:23] offset:1024
    v_mfma_f32_16x16x32_bf16 v[48:51], v[12:15], a[208:211], 0
    v_mfma_f32_16x16x32_bf16 v[48:51], v[16:19], a[212:215], v[48:51]
    s_waitcnt lgkmcnt(0)
    v_mfma_f32_16x16x32_bf16 v[48:51], v[56:59], v[64:67], v[48:51]
    s_mov_b32 exec_hi, 0
    v_cvt_pk_bf16_f32 v52, v44, v45
    v_cvt_pk_bf16_f32 v53, v46, v47
    s_mov_b32 exec_hi, -1
    v_mfma_f32_16x16x32_bf16 v[48:51], v[60:63], v[68:71], v[48:51]
    ds_read_b128 v[64:67], v11 offset:30720
    ds_read_b128 v[68:71], v11 offset:31744
    v_mfma_f32_16x16x32_bf16 v[44:47], v[12:15], a[216:219], 0
    v_mfma_f32_16x16x32_bf16 v[44:47], v[16:19], a[220:223], v[44:47]
    v_mfma_f32_16x16x32_bf16 v[44:47], v[56:59], a[224:227], v[44:47]
    s_mov_b32 exec_lo, 0
    v_cvt_pk_bf16_f32 v52, v48, v49
    v_cvt_pk_bf16_f32 v53, v50, v51
    s_mov_b32 exec_lo, -1
    v_and_b32 v52, 0xfffffffe, v52
    global_store_dwordx2 v5, v[52:53], s[86:87]
    v_mfma_f32_16x16x32_bf16 v[44:47], v[60:63], a[228:231], v[44:47]
    global_load_dwordx4 v[36:39], v2, s[22:23] offset:2048
    s_waitcnt lgkmcnt(0)
    v_mfma_f32_16x16x32_bf16 v[48:51], v[12:15], v[64:67], 0
    v_mfma_f32_16x16x32_bf16 v[48:51], v[16:19], v[68:71], v[48:51]
    ds_read_b128 v[64:67], v11 offset:32768
    ds_read_b128 v[68:71], v11 offset:33792
    v_mfma_f32_16x16x32_bf16 v[48:51], v[56:59], a[232:235], v[48:51]
    s_mov_b32 exec_hi, 0
    v_cvt_pk_bf16_f32 v54, v44, v45
    v_cvt_pk_bf16_f32 v55, v46, v47
    s_mov_b32 exec_hi, -1
    v_mfma_f32_16x16x32_bf16 v[48:51], v[60:63], a[236:239], v[48:51]
    v_mfma_f32_16x16x32_bf16 v[44:47], v[12:15], a[240:243], 0
    v_mfma_f32_16x16x32_bf16 v[44:47], v[16:19], a[244:247], v[44:47]
    s_waitcnt lgkmcnt(0)
    v_mfma_f32_16x16x32_bf16 v[44:47], v[56:59], v[64:67], v[44:47]
    s_mov_b32 exec_lo, 0
    v_cvt_pk_bf16_f32 v54, v48, v49
    v_cvt_pk_bf16_f32 v55, v50, v51
    s_mov_b32 exec_lo, -1
    v_and_b32 v54, 0xfffffffe, v54
    global_store_dwordx2 v5, v[54:55], s[88:89]
    v_mfma_f32_16x16x32_bf16 v[44:47], v[60:63], v[68:71], v[44:47]
    global_load_dwordx4 v[40:43], v2, s[22:23] offset:3072
    v_mfma_f32_16x16x32_bf16 v[48:51], v[12:15], a[248:251], 0
    v_mfma_f32_16x16x32_bf16 v[48:51], v[16:19], a[252:255], v[48:51]
    s_waitcnt vmcnt(8)
    v_mfma_f32_16x16x32_bf16 v[48:51], v[56:59], v[72:75], v[48:51]
    s_mov_b32 exec_hi, 0
    v_cvt_pk_bf16_f32 v52, v44, v45
    v_cvt_pk_bf16_f32 v53, v46, v47
    s_mov_b32 exec_hi, -1
    v_mfma_f32_16x16x32_bf16 v[48:51], v[60:63], v[76:79], v[48:51]
    s_nop 7
    s_mov_b32 exec_lo, 0
    v_cvt_pk_bf16_f32 v52, v48, v49
    v_cvt_pk_bf16_f32 v53, v50, v51
    s_mov_b32 exec_lo, -1
    v_and_b32 v52, 0xfffffffe, v52
    global_store_dwordx2 v5, v[52:53], s[90:91]
    s_cmp_ge_u32 s16, 80
    s_cbranch_scc1 Lnr_117
    v_lshrrev_b32 v0, 4, v2
    v_and_b32 v0, 15, v0
    v_and_b32 v1, 1, v0
    v_lshlrev_b32 v1, 4, v1
    v_mov_b32 v47, 0x3f80
    v_lshlrev_b32 v1, v1, v47
    v_lshrrev_b32 v0, 1, v0
    v_cmp_eq_u32 vcc, 0, v0
    s_nop 1
    v_cndmask_b32 v48, 0, v1, vcc
    v_cmp_eq_u32 vcc, 1, v0
    s_nop 1
    v_cndmask_b32 v49, 0, v1, vcc
    v_cmp_eq_u32 vcc, 2, v0
    s_nop 1
    v_cndmask_b32 v50, 0, v1, vcc
    v_cmp_eq_u32 vcc, 3, v0
    s_nop 1
    v_cndmask_b32 v51, 0, v1, vcc
    s_waitcnt vmcnt(1)
    global_load_dwordx4 v[12:15], v6, s[52:53] offset:0 sc1
    global_load_dwordx4 v[16:19], v6, s[52:53] offset:1024 sc1
    global_load_dwordx4 v[56:59], v6, s[52:53] offset:2048 sc1
    global_load_dwordx4 v[60:63], v6, s[52:53] offset:3072 sc1
    global_load_dwordx4 v[64:67], v2, s[24:25] offset:0
    global_load_dwordx4 v[68:71], v2, s[24:25] offset:1024
    global_load_dwordx4 v[72:75], v2, s[24:25] offset:2048
    global_load_dwordx4 v[76:79], v2, s[24:25] offset:3072
    s_waitcnt vmcnt(4)
    s_branch Lrchk_119
Lrpoll_118:
    global_load_dwordx4 v[12:15], v6, s[52:53] offset:0 sc1
    global_load_dwordx4 v[16:19], v6, s[52:53] offset:1024 sc1
    global_load_dwordx4 v[56:59], v6, s[52:53] offset:2048 sc1
    global_load_dwordx4 v[60:63], v6, s[52:53] offset:3072 sc1
    s_waitcnt vmcnt(0)
Lrchk_119:
    v_or3_b32 v0, v12, v14, v16
    v_or3_b32 v1, v18, v56, v58
    v_or3_b32 v0, v0, v60, v62
    v_or_b32 v0, v0, v1
    v_and_b32 v0, 1, v0
    v_cmp_ne_u32 vcc, 0, v0
    s_sub_u32 s19, s19, 1
    s_cbranch_scc1 Lend_1
    s_cbranch_vccnz Lrpoll_118
    v_mfma_f32_16x16x32_bf16 v[44:47], v[12:15], v[48:51], 0
    v_mfma_f32_16x16x32_bf16 v[44:47], v[16:19], v[48:51], v[44:47]
    v_mfma_f32_16x16x32_bf16 v[44:47], v[56:59], v[48:51], v[44:47]
    v_mfma_f32_16x16x32_bf16 v[44:47], v[60:63], v[48:51], v[44:47]
    v_mov_b32 v1, -1
    s_nop 6
    v_permlane32_swap_b32 v44, v46
    v_permlane32_swap_b32 v45, v47
    v_add_f32 v44, v44, v46
    v_add_f32 v45, v45, v47
    v_cvt_pk_bf16_f32 v0, v44, v45
    v_min_u32 v0, 0xfffffffe, v0
    s_mov_b32 exec_lo, 0x00ff00ff
    s_mov_b32 exec_hi, 0x00ff00ff
    global_store_dword v7, v0, s[80:81]
    global_store_dword v7, v1, s[78:79]
    s_mov_b64 exec, -1
    s_branch Lred_116
Lnr_117:
    global_load_dwordx4 v[64:67], v2, s[24:25] offset:0
    global_load_dwordx4 v[68:71], v2, s[24:25] offset:1024
    global_load_dwordx4 v[72:75], v2, s[24:25] offset:2048
    global_load_dwordx4 v[76:79], v2, s[24:25] offset:3072
Lred_116:
    v_mov_b32 v12, 0
    v_mov_b32 v56, 0
    v_mov_b32 v28, 0
    v_mov_b32 v13, 0
    v_mov_b32 v57, 0
    v_mov_b32 v29, 0
    v_mov_b32 v14, 0
    v_mov_b32 v58, 0
    v_mov_b32 v30, 0
    v_mov_b32 v15, 0
    v_mov_b32 v59, 0
    v_mov_b32 v31, 0
    v_mov_b32 v16, 0
    v_mov_b32 v60, 0
    v_mov_b32 v32, 0
    v_mov_b32 v17, 0
    v_mov_b32 v61, 0
    v_mov_b32 v33, 0
    v_mov_b32 v18, 0
    v_mov_b32 v62, 0
    v_mov_b32 v34, 0
    v_mov_b32 v19, 0
    v_mov_b32 v63, 0
    v_mov_b32 v35, 0
    s_barrier
    s_add_u32 s18, s18, 1
LstepB_101:
    s_cmp_ge_u32 s10, 2
    s_cbranch_scc0 Lsk_121
    v_mov_b32 v52, 0
    v_mov_b32 v53, 0
    v_mov_b32 v54, 0
    v_mov_b32 v55, 0
Lsk_121:
Lgpoll_120:
    global_load_dwordx4 v[44:47], v3, s[72:73] sc1
    global_load_dwordx4 v[48:51], v3, s[74:75] sc1
    s_cmp_ge_u32 s10, 2
    s_cbranch_scc1 Lsk_122
    global_load_dwordx4 v[52:55], v3, s[76:77] sc1
Lsk_122:
    s_waitcnt vmcnt(0)
    v_max3_u32 v0, v44, v45, v46
    v_max3_u32 v1, v47, v48, v49
    v_max3_u32 v0, v0, v50, v51
    v_max3_u32 v1, v1, v52, v53
    v_max3_u32 v0, v0, v54, v55
    v_max_u32 v0, v0, v1
    v_cmp_eq_u32 vcc, -1, v0
    s_sub_u32 s19, s19, 1
    s_cbranch_scc1 Lend_1
    s_cbranch_vccnz Lgpoll_120
    s_lshl_b32 s13, s10, 10
    v_add_u32 v1, s13, v2
    ds_write_b128 v1, v[44:47] offset:0
    ds_write_b128 v1, v[48:51] offset:4096
    s_cmp_ge_u32 s10, 2
    s_cbranch_scc1 Lsk_123
    ds_write_b128 v1, v[52:55] offset:8192
Lsk_123:
    v_add_u32 v11, s17, v2
    s_waitcnt lgkmcnt(0)
    s_barrier
    ds_read_b128 v[44:47], v2 offset:0
    ds_read_b128 v[48:51], v2 offset:1024
    ds_read_b128 v[52:55], v2 offset:2048
    s_waitcnt lgkmcnt(2)
    v_smfmac_f32_16x16x64_bf16 v[56:59], v[44:47], v[64:71], v4
    ds_read_b128 v[64:67], v11 offset:0
    ds_read_b128 v[68:71], v11 offset:1024
    v_smfmac_f32_16x16x64_bf16 v[60:63], v[44:47], v[72:79], v4
    ds_read_b128 v[72:75], v11 offset:2048
    ds_read_b128 v[76:79], v11 offset:3072
    v_smfmac_f32_16x16x64_bf16 v[12:15], v[44:47], v[20:27], v4
    v_smfmac_f32_16x16x64_bf16 v[16:19], v[44:47], v[36:43], v4
    global_load_dwordx4 v[20:23], v2, s[26:27] offset:0
    v_smfmac_f32_16x16x64_bf16 v[28:31], v[44:47], a[56:63], v4
    v_smfmac_f32_16x16x64_bf16 v[32:35], v[44:47], a[64:71], v4
    global_load_dwordx4 v[24:27], v2, s[26:27] offset:1024
    ds_read_b128 v[44:47], v2 offset:3072
    s_waitcnt lgkmcnt(6)
    v_smfmac_f32_16x16x64_bf16 v[12:15], v[48:51], v[80:87], v4
    v_smfmac_f32_16x16x64_bf16 v[16:19], v[48:51], v[88:95], v4
    global_load_dwordx4 v[36:39], v2, s[26:27] offset:2048
    v_smfmac_f32_16x16x64_bf16 v[56:59], v[48:51], v[200:207], v4
    v_smfmac_f32_16x16x64_bf16 v[60:63], v[48:51], v[208:215], v4
    global_load_dwordx4 v[40:43], v2, s[26:27] offset:3072
    s_waitcnt lgkmcnt(3)
    v_smfmac_f32_16x16x64_bf16 v[28:31], v[48:51], v[64:71], v4
    ds_read_b128 v[64:67], v11 offset:4096
    ds_read_b128 v[68:71], v11 offset:5120
    v_smfmac_f32_16x16x64_bf16 v[32:35], v[48:51], a[72:79], v4
    ds_read_b128 v[48:51], v2 offset:4096
    v_smfmac_f32_16x16x64_bf16 v[12:15], v[52:55], v[96:103], v4
    v_smfmac_f32_16x16x64_bf16 v[16:19], v[52:55], v[104:111], v4
    s_waitcnt lgkmcnt(4)
    v_smfmac_f32_16x16x64_bf16 v[56:59], v[52:55], v[72:79], v4
    ds_read_b128 v[72:75], v11 offset:6144
    ds_read_b128 v[76:79], v11 offset:7168
    v_smfmac_f32_16x16x64_bf16 v[60:63], v[52:55], v[216:223], v4
    v_smfmac_f32_16x16x64_bf16 v[28:31], v[52:55], a[80:87], v4
    v_smfmac_f32_16x16x64_bf16 v[32:35], v[52:55], a[88:95], v4
    ds_read_b128 v[52:55], v2 offset:5120
    s_waitcnt lgkmcnt(6)
    v_smfmac_f32_16x16x64_bf16 v[12:15], v[44:47], v[112:119], v4
    s_waitcnt lgkmcnt(4)
    v_smfmac_f32_16x16x64_bf16 v[16:19], v[44:47], v[64:71], v4
    ds_read_b128 v[64:67], v11 offset:8192
    ds_read_b128 v[68:71], v11 offset:9216
    v_smfmac_f32_16x16x64_bf16 v[56:59], v[44:47], v[224:231], v4
    v_smfmac_f32_16x16x64_bf16 v[60:63], v[44:47], v[232:239], v4
    v_smfmac_f32_16x16x64_bf16 v[28:31], v[44:47], a[96:103], v4
    s_waitcnt lgkmcnt(3)
    v_smfmac_f32_16x16x64_bf16 v[32:35], v[44:47], v[72:79], v4
    ds_read_b128 v[72:75], v11 offset:10240
    ds_read_b128 v[76:79], v11 offset:11264
    ds_read_b128 v[44:47], v2 offset:6144
    v_smfmac_f32_16x16x64_bf16 v[12:15], v[48:51], v[120:127], v4
    v_smfmac_f32_16x16x64_bf16 v[16:19], v[48:51], v[128:135], v4
    v_smfmac_f32_16x16x64_bf16 v[56:59], v[48:51], v[240:247], v4
    s_waitcnt lgkmcnt(3)
    v_smfmac_f32_16x16x64_bf16 v[60:63], v[48:51], v[64:71], v4
    ds_read_b128 v[64:67], v11 offset:12288
    ds_read_b128 v[68:71], v11 offset:13312
    v_smfmac_f32_16x16x64_bf16 v[28:31], v[48:51], a[104:111], v4
    v_smfmac_f32_16x16x64_bf16 v[32:35], v[48:51], a[112:119], v4
    ds_read_b128 v[48:51], v2 offset:7168
    s_waitcnt lgkmcnt(4)
    v_smfmac_f32_16x16x64_bf16 v[12:15], v[52:55], v[72:79], v4
    ds_read_b128 v[72:75], v11 offset:16384
    ds_read_b128 v[76:79], v11 offset:17408
    v_smfmac_f32_16x16x64_bf16 v[16:19], v[52:55], v[136:143], v4
    v_smfmac_f32_16x16x64_bf16 v[56:59], v[52:55], v[248:255], v4
    v_smfmac_f32_16x16x64_bf16 v[60:63], v[52:55], a[0:7], v4
    s_waitcnt vmcnt(2)
    v_smfmac_f32_16x16x64_bf16 v[28:31], v[52:55], v[20:27], v4
    s_waitcnt vmcnt(0)
    v_smfmac_f32_16x16x64_bf16 v[32:35], v[52:55], v[36:43], v4
    global_load_dwordx4 v[20:23], v2, s[28:29] offset:0
    ds_read_b128 v[52:55], v2 offset:8192
    s_waitcnt lgkmcnt(6)
    v_smfmac_f32_16x16x64_bf16 v[12:15], v[44:47], v[144:151], v4
    v_smfmac_f32_16x16x64_bf16 v[16:19], v[44:47], v[152:159], v4
    global_load_dwordx4 v[24:27], v2, s[28:29] offset:1024
    v_smfmac_f32_16x16x64_bf16 v[56:59], v[44:47], a[8:15], v4
    v_smfmac_f32_16x16x64_bf16 v[60:63], v[44:47], a[16:23], v4
    global_load_dwordx4 v[36:39], v2, s[28:29] offset:2048
    s_waitcnt lgkmcnt(4)
    v_smfmac_f32_16x16x64_bf16 v[28:31], v[44:47], v[64:71], v4
    ds_read_b128 v[64:67], v11 offset:14336
    ds_read_b128 v[68:71], v11 offset:15360
    v_smfmac_f32_16x16x64_bf16 v[32:35], v[44:47], a[120:127], v4
    global_load_dwordx4 v[40:43], v2, s[28:29] offset:3072
    ds_read_b128 v[44:47], v2 offset:9216
    s_waitcnt lgkmcnt(6)
    v_smfmac_f32_16x16x64_bf16 v[12:15], v[48:51], v[160:167], v4
    s_waitcnt lgkmcnt(4)
    v_smfmac_f32_16x16x64_bf16 v[16:19], v[48:51], v[72:79], v4
    ds_read_b128 v[72:75], v11 offset:18432
    ds_read_b128 v[76:79], v11 offset:19456
    s_waitcnt lgkmcnt(3)
    v_smfmac_f32_16x16x64_bf16 v[56:59], v[48:51], v[64:71], v4
    ds_read_b128 v[64:67], v11 offset:20480
    ds_read_b128 v[68:71], v11 offset:21504
    v_smfmac_f32_16x16x64_bf16 v[60:63], v[48:51], a[24:31], v4
    v_smfmac_f32_16x16x64_bf16 v[28:31], v[48:51], a[128:135], v4
    v_smfmac_f32_16x16x64_bf16 v[32:35], v[48:51], a[136:143], v4
    v_smfmac_f32_16x16x64_bf16 v[12:15], v[52:55], v[168:175], v4
    v_smfmac_f32_16x16x64_bf16 v[16:19], v[52:55], v[176:183], v4
    v_smfmac_f32_16x16x64_bf16 v[56:59], v[52:55], a[32:39], v4
    v_smfmac_f32_16x16x64_bf16 v[60:63], v[52:55], a[40:47], v4
    v_smfmac_f32_16x16x64_bf16 v[28:31], v[52:55], a[144:151], v4
    s_waitcnt lgkmcnt(2)
    v_smfmac_f32_16x16x64_bf16 v[32:35], v[52:55], v[72:79], v4
    v_smfmac_f32_16x16x64_bf16 v[12:15], v[44:47], v[184:191], v4
    v_smfmac_f32_16x16x64_bf16 v[16:19], v[44:47], v[192:199], v4
    v_smfmac_f32_16x16x64_bf16 v[56:59], v[44:47], a[48:55], v4
    s_waitcnt lgkmcnt(0)
    v_smfmac_f32_16x16x64_bf16 v[60:63], v[44:47], v[64:71], v4
    s_waitcnt vmcnt(2)
    v_smfmac_f32_16x16x64_bf16 v[28:31], v[44:47], v[20:27], v4
    s_waitcnt vmcnt(0)
    v_smfmac_f32_16x16x64_bf16 v[32:35], v[44:47], v[36:43], v4
    global_load_dwordx4 v[36:39], v2, s[60:61] sc1
    s_nop 4
    v_permlane32_swap_b32 v12, v16
    v_permlane32_swap_b32 v13, v17
    v_permlane32_swap_b32 v14, v18
    v_permlane32_swap_b32 v15, v19
    v_pk_add_f32 v[12:13], v[12:13], v[16:17]
    v_pk_add_f32 v[14:15], v[14:15], v[18:19]
    v_cvt_pk_bf16_f32 v12, v12, v13
    v_cvt_pk_bf16_f32 v13, v14, v15
    ds_write_b64 v8, v[12:13] offset:18432
    global_load_dwordx4 v[40:43], v2, s[60:61] offset:1024 sc1
    v_permlane32_swap_b32 v56, v60
    v_permlane32_swap_b32 v57, v61
    v_permlane32_swap_b32 v58, v62
    v_permlane32_swap_b32 v59, v63
    v_pk_add_f32 v[56:57], v[56:57], v[60:61]
    v_pk_add_f32 v[58:59], v[58:59], v[62:63]
    v_cvt_pk_bf16_f32 v56, v56, v57
    v_cvt_pk_bf16_f32 v57, v58, v59
    ds_write_b64 v8, v[56:57] offset:20480
    ds_read_b128 v[20:23], v2 offset:10240
    ds_read_b128 v[24:27], v2 offset:14336
    v_lshlrev_b32 v1, 2, v2
    s_mov_b32 m0, 22528
    s_nop 0
    s_waitcnt lgkmcnt(0)
    s_barrier
    ds_read_b64_tr_b16 v[64:65], v9 offset:18432
    ds_read_b64_tr_b16 v[66:67], v9 offset:18496
    ds_read_b64_tr_b16 v[12:13], v9 offset:20480
    ds_read_b64_tr_b16 v[14:15], v9 offset:20544
    ds_read_b64_tr_b16 v[68:69], v9 offset:18944
    ds_read_b64_tr_b16 v[70:71], v9 offset:19008
    ds_read_b64_tr_b16 v[16:17], v9 offset:20992
    ds_read_b64_tr_b16 v[18:19], v9 offset:21056
    ds_read_b128 v[72:75], v2 offset:11264
    ds_read_b128 v[76:79], v2 offset:15360
    s_waitcnt lgkmcnt(8)
    s_waitcnt lgkmcnt(6)
    v_mfma_f32_16x16x32_bf16 v[44:47], v[12:15], v[64:67], 0
    v_mfma_f32_16x16x32_bf16 v[48:51], v[20:23], v[64:67], 0
    ds_read_b128 v[20:23], v2 offset:12288
    v_mfma_f32_16x16x32_bf16 v[52:55], v[24:27], v[64:67], 0
    ds_read_b128 v[24:27], v2 offset:16384
    ds_read_b64_tr_b16 v[64:65], v9 offset:19456
    ds_read_b64_tr_b16 v[66:67], v9 offset:19520
    ds_read_b64_tr_b16 v[56:57], v9 offset:21504
    ds_read_b64_tr_b16 v[58:59], v9 offset:21568
    s_waitcnt lgkmcnt(10)
    s_waitcnt lgkmcnt(8)
    v_mfma_f32_16x16x32_bf16 v[44:47], v[16:19], v[68:71], v[44:47]
    s_waitcnt lgkmcnt(7)
    v_mfma_f32_16x16x32_bf16 v[48:51], v[72:75], v[68:71], v[48:51]
    ds_read_b128 v[72:75], v2 offset:13312
    s_waitcnt lgkmcnt(7)
    v_mfma_f32_16x16x32_bf16 v[52:55], v[76:79], v[68:71], v[52:55]
    ds_read_b128 v[76:79], v2 offset:17408
    ds_read_b64_tr_b16 v[68:69], v9 offset:19968
    ds_read_b64_tr_b16 v[70:71], v9 offset:20032
    ds_read_b64_tr_b16 v[60:61], v9 offset:22016
    ds_read_b64_tr_b16 v[62:63], v9 offset:22080
    s_waitcnt lgkmcnt(8)
    s_waitcnt lgkmcnt(6)
    v_mfma_f32_16x16x32_bf16 v[44:47], v[56:59], v[64:67], v[44:47]
    v_mfma_f32_16x16x32_bf16 v[48:51], v[20:23], v[64:67], v[48:51]
    v_mfma_f32_16x16x32_bf16 v[52:55], v[24:27], v[64:67], v[52:55]
    s_waitcnt lgkmcnt(2)
    s_waitcnt lgkmcnt(0)
    v_mfma_f32_16x16x32_bf16 v[44:47], v[60:63], v[68:71], v[44:47]
    v_mfma_f32_16x16x32_bf16 v[48:51], v[72:75], v[68:71], v[48:51]
    v_mfma_f32_16x16x32_bf16 v[52:55], v[76:79], v[68:71], v[52:55]
    v_permlane32_swap_b32 v28, v32
    v_permlane32_swap_b32 v29, v33
    v_permlane32_swap_b32 v30, v34
    v_permlane32_swap_b32 v31, v35
    v_pk_add_f32 v[28:29], v[28:29], v[32:33]
    v_pk_add_f32 v[30:31], v[30:31], v[34:35]
    v_cvt_pk_bf16_f32 v28, v28, v29
    v_cvt_pk_bf16_f32 v29, v30, v31
    v_lshrrev_b32 v1, 1, v2
    global_store_dwordx2 v1, v[28:29], s[64:65] sc1
    s_cmp_lg_u32 s10, 0
    s_cbranch_scc1 Lkmn_125
    global_store_dwordx4 v2, v[12:15], s[62:63] sc1
    s_branch Lkm_124
Lkmn_125:
    s_cmp_lg_u32 s10, 1
    s_cbranch_scc1 Lkmn_126
    global_store_dwordx4 v2, v[16:19], s[62:63] sc1
    s_branch Lkm_124
Lkmn_126:
    s_cmp_lg_u32 s10, 2
    s_cbranch_scc1 Lkmn_127
    global_store_dwordx4 v2, v[56:59], s[62:63] sc1
    s_branch Lkm_124
Lkmn_127:
    global_store_dwordx4 v2, v[60:63], s[62:63] sc1
Lkm_124:
    s_cmp_eq_u32 s18, 63
    s_cbranch_scc1 Lfin_91
    s_barrier
    s_mov_b32 m0, s21
    s_nop 0
    global_load_lds_dwordx4 v2, s[58:59] sc1
    s_add_u32 m0, s21, 1024
    v_add_u32 v1, 1024, v2
    global_load_lds_dwordx4 v1, s[58:59] sc1
    s_add_u32 s58, s58, 262144
    s_addc_u32 s59, s59, 0
    v_max3_f32 v0, v44, v45, v46
    v_max3_f32 v1, v47, v48, v49
    v_max3_f32 v0, v0, v50, v51
    v_max3_f32 v1, v1, v52, v53
    v_max3_f32 v0, v0, v54, v55
    v_max_f32 v0, v0, v1
    v_mov_b32 v1, v0
    s_nop 1
    v_permlane16_swap_b32 v0, v1
    v_max_f32 v0, v0, v1
    v_mov_b32 v1, v0
    s_nop 1
    v_permlane32_swap_b32 v0, v1
    v_max_f32 v0, v0, v1
    v_mul_f32 v0, s20, v0
    v_fma_f32 v48, v48, s20, -v0
    v_fma_f32 v49, v49, s20, -v0
    v_fma_f32 v50, v50, s20, -v0
    v_fma_f32 v51, v51, s20, -v0
    v_fma_f32 v52, v52, s20, -v0
    v_fma_f32 v53, v53, s20, -v0
    v_fma_f32 v54, v54, s20, -v0
    v_fma_f32 v55, v55, s20, -v0
    v_fma_f32 v44, v44, s20, -v0
    v_fma_f32 v45, v45, s20, -v0
    v_fma_f32 v46, v46, s20, -v0
    v_fma_f32 v47, v47, s20, -v0
    v_exp_f32 v48, v48
    v_exp_f32 v49, v49
    v_exp_f32 v50, v50
    v_exp_f32 v51, v51
    v_exp_f32 v52, v52
    v_exp_f32 v53, v53
    v_exp_f32 v54, v54
    v_exp_f32 v55, v55
    v_cvt_pk_bf16_f32 v12, v48, v49
    v_cvt_pk_bf16_f32 v13, v50, v51
    v_cvt_pk_bf16_f32 v14, v52, v53
    v_cvt_pk_bf16_f32 v15, v54, v55
    v_mov_b32 v56, 0x3f803f80
    v_mov_b32 v57, 0x3f803f80
    v_mov_b32 v58, 0x3f803f80
    v_mov_b32 v59, 0x3f803f80
    v_exp_f32 v44, v44
    v_exp_f32 v45, v45
    v_exp_f32 v46, v46
    v_exp_f32 v47, v47
    s_waitcnt vmcnt(4)
    s_cmp_lg_u32 s10, 3
    s_cbranch_scc1 Lpg_129
    s_mov_b64 exec, 1
    v_mov_b32 v0, s101
    v_mov_b32 v1, s18
    global_store_dword v0, v1, s[4:5] sc1
    s_mov_b64 exec, -1
Lpg_129:
    v_mfma_f32_16x16x32_bf16 v[72:75], v[56:59], v[12:15], 0
    v_cvt_pk_bf16_f32 v0, v44, v45
    v_cvt_pk_bf16_f32 v1, v46, v47
    v_mfma_f32_16x16x32_bf16 v[20:23], v[36:39], v[12:15], 0
    v_cndmask_b32_e64 v16, 0, v0, s[96:97]
    v_cndmask_b32_e64 v17, 0, v1, s[96:97]
    v_mfma_f32_16x16x32_bf16 v[24:27], v[40:43], v[12:15], 0
    v_cndmask_b32_e64 v18, v0, 0, s[96:97]
    v_cndmask_b32_e64 v19, v1, 0, s[96:97]
    ds_read_b128 v[64:67], v11 offset:22528
    ds_read_b128 v[68:71], v11 offset:23552
    s_add_u32 s60, s60, 262144
    s_addc_u32 s61, s61, 0
    s_add_u32 s56, s56, 262144
    s_addc_u32 s57, s57, 0
    s_add_u32 s62, s62, 131072
    s_addc_u32 s63, s63, 0
    s_add_u32 s64, s64, 65536
    s_addc_u32 s65, s65, 0
    s_nop 1
    v_mfma_f32_16x16x16_bf16 v[72:75], v[56:57], v[16:17], v[72:75]
    v_mfma_f32_16x16x16_bf16 v[20:23], v[28:29], v[16:17], v[20:23]
    v_mfma_f32_16x16x16_bf16 v[24:27], v[28:29], v[18:19], v[24:27]
    v_and_b32 v49, 0x70, v2
    v_lshrrev_b32 v48, 8, v2
    v_lshl_add_u32 v48, v48, 7, v49
    s_nop 2
    v_rcp_f32 v0, v72
    s_nop 1
    v_pk_mul_f32 v[20:21], v[20:21], v[0:1] op_sel_hi:[1,0]
    v_pk_mul_f32 v[22:23], v[22:23], v[0:1] op_sel_hi:[1,0]
    v_pk_mul_f32 v[24:25], v[24:25], v[0:1] op_sel_hi:[1,0]
    v_pk_mul_f32 v[26:27], v[26:27], v[0:1] op_sel_hi:[1,0]
    v_cvt_pk_bf16_f32 v44, v20, v21
    v_cvt_pk_bf16_f32 v45, v22, v23
    v_cvt_pk_bf16_f32 v46, v24, v25
    v_cvt_pk_bf16_f32 v47, v26, v27
    s_mov_b32 exec_lo, 0x00ff00ff
    s_mov_b32 exec_hi, 0x00ff00ff
    ds_write2_b32 v10, v44, v45 offset0:0 offset1:2
    ds_write2_b32 v10, v46, v47 offset0:64 offset1:66
    s_mov_b64 exec, -1
    global_load_dwordx4 v[72:75], v2, s[30:31] offset:0
    global_load_dwordx4 v[76:79], v2, s[30:31] offset:1024
    s_waitcnt lgkmcnt(0)
    s_barrier
    ds_read_b128 v[12:15], v48 offset:18432
    ds_read_b128 v[16:19], v48 offset:18944
    ds_read_b128 v[56:59], v48 offset:19456
    ds_read_b128 v[60:63], v48 offset:19968
    s_waitcnt lgkmcnt(3)
    v_mfma_f32_16x16x32_bf16 v[44:47], v[12:15], a[152:155], 0
    s_waitcnt lgkmcnt(2)
    v_mfma_f32_16x16x32_bf16 v[44:47], v[16:19], a[156:159], v[44:47]
    s_waitcnt lgkmcnt(1)
    v_mfma_f32_16x16x32_bf16 v[44:47], v[56:59], a[160:163], v[44:47]
    s_waitcnt lgkmcnt(0)
    v_mfma_f32_16x16x32_bf16 v[44:47], v[60:63], a[164:167], v[44:47]
    v_mfma_f32_16x16x32_bf16 v[48:51], v[12:15], v[64:67], 0
    v_mfma_f32_16x16x32_bf16 v[48:51], v[16:19], v[68:71], v[48:51]
    ds_read_b128 v[64:67], v11 offset:24576
    ds_read_b128 v[68:71], v11 offset:25600
    v_mfma_f32_16x16x32_bf16 v[48:51], v[56:59], a[168:171], v[48:51]
    s_mov_b32 exec_hi, 0
    v_cvt_pk_bf16_f32 v52, v44, v45
    v_cvt_pk_bf16_f32 v53, v46, v47
    s_mov_b32 exec_hi, -1
    v_mfma_f32_16x16x32_bf16 v[48:51], v[60:63], a[172:175], v[48:51]
    v_mfma_f32_16x16x32_bf16 v[44:47], v[12:15], a[176:179], 0
    v_mfma_f32_16x16x32_bf16 v[44:47], v[16:19], a[180:183], v[44:47]
    s_waitcnt lgkmcnt(0)
    v_mfma_f32_16x16x32_bf16 v[44:47], v[56:59], v[64:67], v[44:47]
    s_mov_b32 exec_lo, 0
    v_cvt_pk_bf16_f32 v52, v48, v49
    v_cvt_pk_bf16_f32 v53, v50, v51
    s_mov_b32 exec_lo, -1
    v_or_b32 v52, 1, v52
    global_store_dwordx2 v5, v[52:53], s[82:83]
    v_mfma_f32_16x16x32_bf16 v[44:47], v[60:63], v[68:71], v[44:47]
    global_load_dwordx4 v[20:23], v2, s[22:23] offset:0
    ds_read_b128 v[64:67], v11 offset:26624
    ds_read_b128 v[68:71], v11 offset:27648
    v_mfma_f32_16x16x32_bf16 v[48:51], v[12:15], a[184:187], 0
    v_mfma_f32_16x16x32_bf16 v[48:51], v[16:19], a[188:191], v[48:51]
    v_mfma_f32_16x16x32_bf16 v[48:51], v[56:59], a[192:195], v[48:51]
    s_mov_b32 exec_hi, 0
    v_cvt_pk_bf16_f32 v54, v44, v45
    v_cvt_pk_bf16_f32 v55, v46, v47
    s_mov_b32 exec_hi, -1
    v_mfma_f32_16x16x32_bf16 v[48:51], v[60:63], a[196:199], v[48:51]
    s_waitcnt lgkmcnt(0)
    v_mfma_f32_16x16x32_bf16 v[44:47], v[12:15], v[64:67], 0
    v_mfma_f32_16x16x32_bf16 v[44:47], v[16:19], v[68:71], v[44:47]
    ds_read_b128 v[64:67], v11 offset:28672
    ds_read_b128 v[68:71], v11 offset:29696
    v_mfma_f32_16x16x32_bf16 v[44:47], v[56:59], a[200:203], v[44:47]
    s_mov_b32 exec_lo, 0
    v_cvt_pk_bf16_f32 v54, v48, v49
    v_cvt_pk_bf16_f32 v55, v50, v51
    s_mov_b32 exec_lo, -1
    v_or_b32 v54, 1, v54
    global_store_dwordx2 v5, v[54:55], s[84:85]
    v_mfma_f32_16x16x32_bf16 v[44:47], v[60:63], a[204:207], v[44:47]
    global_load_dwordx4 v[24:27], v2, s[22:23] offset:1024
    v_mfma_f32_16x16x32_bf16 v[48:51], v[12:15], a[208:211], 0
    v_mfma_f32_16x16x32_bf16 v[48:51], v[16:19], a[212:215], v[48:51]
    s_waitcnt lgkmcnt(0)
    v_mfma_f32_16x16x32_bf16 v[48:51], v[56:59], v[64:67], v[48:51]
    s_mov_b32 exec_hi, 0
    v_cvt_pk_bf16_f32 v52, v44, v45
    v_cvt_pk_bf16_f32 v53, v46, v47
    s_mov_b32 exec_hi, -1
    v_mfma_f32_16x16x32_bf16 v[48:51], v[60:63], v[68:71], v[48:51]
    ds_read_b128 v[64:67], v11 offset:30720
    ds_read_b128 v[68:71], v11 offset:31744
    v_mfma_f32_16x16x32_bf16 v[44:47], v[12:15], a[216:219], 0
    v_mfma_f32_16x16x32_bf16 v[44:47], v[16:19], a[220:223], v[44:47]
    v_mfma_f32_16x16x32_bf16 v[44:47], v[56:59], a[224:227], v[44:47]
    s_mov_b32 exec_lo, 0
    v_cvt_pk_bf16_f32 v52, v48, v49
    v_cvt_pk_bf16_f32 v53, v50, v51
    s_mov_b32 exec_lo, -1
    v_or_b32 v52, 1, v52
    global_store_dwordx2 v5, v[52:53], s[86:87]
    v_mfma_f32_16x16x32_bf16 v[44:47], v[60:63], a[228:231], v[44:47]
    global_load_dwordx4 v[36:39], v2, s[22:23] offset:2048
    s_waitcnt lgkmcnt(0)
    v_mfma_f32_16x16x32_bf16 v[48:51], v[12:15], v[64:67], 0
    v_mfma_f32_16x16x32_bf16 v[48:51], v[16:19], v[68:71], v[48:51]
    ds_read_b128 v[64:67], v11 offset:32768
    ds_read_b128 v[68:71], v11 offset:33792
    v_mfma_f32_16x16x32_bf16 v[48:51], v[56:59], a[232:235], v[48:51]
    s_mov_b32 exec_hi, 0
    v_cvt_pk_bf16_f32 v54, v44, v45
    v_cvt_pk_bf16_f32 v55, v46, v47
    s_mov_b32 exec_hi, -1
    v_mfma_f32_16x16x32_bf16 v[48:51], v[60:63], a[236:239], v[48:51]
    v_mfma_f32_16x16x32_bf16 v[44:47], v[12:15], a[240:243], 0
    v_mfma_f32_16x16x32_bf16 v[44:47], v[16:19], a[244:247], v[44:47]
    s_waitcnt lgkmcnt(0)
    v_mfma_f32_16x16x32_bf16 v[44:47], v[56:59], v[64:67], v[44:47]
    s_mov_b32 exec_lo, 0
    v_cvt_pk_bf16_f32 v54, v48, v49
    v_cvt_pk_bf16_f32 v55, v50, v51
    s_mov_b32 exec_lo, -1
    v_or_b32 v54, 1, v54
    global_store_dwordx2 v5, v[54:55], s[88:89]
    v_mfma_f32_16x16x32_bf16 v[44:47], v[60:63], v[68:71], v[44:47]
    global_load_dwordx4 v[40:43], v2, s[22:23] offset:3072
    v_mfma_f32_16x16x32_bf16 v[48:51], v[12:15], a[248:251], 0
    v_mfma_f32_16x16x32_bf16 v[48:51], v[16:19], a[252:255], v[48:51]
    s_waitcnt vmcnt(8)
    v_mfma_f32_16x16x32_bf16 v[48:51], v[56:59], v[72:75], v[48:51]
    s_mov_b32 exec_hi, 0
    v_cvt_pk_bf16_f32 v52, v44, v45
    v_cvt_pk_bf16_f32 v53, v46, v47
    s_mov_b32 exec_hi, -1
    v_mfma_f32_16x16x32_bf16 v[48:51], v[60:63], v[76:79], v[48:51]
    s_nop 7
    s_mov_b32 exec_lo, 0
    v_cvt_pk_bf16_f32 v52, v48, v49
    v_cvt_pk_bf16_f32 v53, v50, v51
    s_mov_b32 exec_lo, -1
    v_or_b32 v52, 1, v52
    global_store_dwordx2 v5, v[52:53], s[90:91]
    s_cmp_ge_u32 s16, 80
    s_cbranch_scc1 Lnr_131
    v_lshrrev_b32 v0, 4, v2
    v_and_b32 v0, 15, v0
    v_and_b32 v1, 1, v0
    v_lshlrev_b32 v1, 4, v1
    v_mov_b32 v47, 0x3f80
    v_lshlrev_b32 v1, v1, v47
    v_lshrrev_b32 v0, 1, v0
    v_cmp_eq_u32 vcc, 0, v0
    s_nop 1
    v_cndmask_b32 v48, 0, v1, vcc
    v_cmp_eq_u32 vcc, 1, v0
    s_nop 1
    v_cndmask_b32 v49, 0, v1, vcc
    v_cmp_eq_u32 vcc, 2, v0
    s_nop 1
    v_cndmask_b32 v50, 0, v1, vcc
    v_cmp_eq_u32 vcc, 3, v0
    s_nop 1
    v_cndmask_b32 v51, 0, v1, vcc
    s_waitcnt vmcnt(1)
    global_load_dwordx4 v[12:15], v6, s[52:53] offset:0 sc1
    global_load_dwordx4 v[16:19], v6, s[52:53] offset:1024 sc1
    global_load_dwordx4 v[56:59], v6, s[52:53] offset:2048 sc1
    global_load_dwordx4 v[60:63], v6, s[52:53] offset:3072 sc1
    global_load_dwordx4 v[64:67], v2, s[24:25] offset:0
    global_load_dwordx4 v[68:71], v2, s[24:25] offset:1024
    global_load_dwordx4 v[72:75], v2, s[24:25] offset:2048
    global_load_dwordx4 v[76:79], v2, s[24:25] offset:3072
    s_waitcnt vmcnt(4)
    s_branch Lrchk_133
Lrpoll_132:
    global_load_dwordx4 v[12:15], v6, s[52:53] offset:0 sc1
    global_load_dwordx4 v[16:19], v6, s[52:53] offset:1024 sc1
    global_load_dwordx4 v[56:59], v6, s[52:53] offset:2048 sc1
    global_load_dwordx4 v[60:63], v6, s[52:53] offset:3072 sc1
    s_waitcnt vmcnt(0)
Lrchk_133:
    v_and_b32 v0, v12, v14
    v_and_b32 v1, v16, v18
    v_and_b32 v0, v0, v56
    v_and_b32 v1, v1, v58
    v_and_b32 v0, v0, v60
    v_and_b32 v1, v1, v62
    v_and_b32 v0, v0, v1
    v_and_b32 v0, 1, v0
    v_cmp_eq_u32 vcc, 0, v0
    s_sub_u32 s19, s19, 1
    s_cbranch_scc1 Lend_1
    s_cbranch_vccnz Lrpoll_132
    v_mfma_f32_16x16x32_bf16 v[44:47], v[12:15], v[48:51], 0
    v_mfma_f32_16x16x32_bf16 v[44:47], v[16:19], v[48:51], v[44:47]
    v_mfma_f32_16x16x32_bf16 v[44:47], v[56:59], v[48:51], v[44:47]
    v_mfma_f32_16x16x32_bf16 v[44:47], v[60:63], v[48:51], v[44:47]
    v_mov_b32 v1, -1
    s_nop 6
    v_permlane32_swap_b32 v44, v46
    v_permlane32_swap_b32 v45, v47
    v_add_f32 v44, v44, v46
    v_add_f32 v45, v45, v47
    v_cvt_pk_bf16_f32 v0, v44, v45
    v_min_u32 v0, 0xfffffffe, v0
    s_mov_b32 exec_lo, 0x00ff00ff
    s_mov_b32 exec_hi, 0x00ff00ff
    global_store_dword v7, v0, s[78:79]
    global_store_dword v7, v1, s[80:81]
    s_mov_b64 exec, -1
    s_branch Lred_130
Lnr_131:
    global_load_dwordx4 v[64:67], v2, s[24:25] offset:0
    global_load_dwordx4 v[68:71], v2, s[24:25] offset:1024
    global_load_dwordx4 v[72:75], v2, s[24:25] offset:2048
    global_load_dwordx4 v[76:79], v2, s[24:25] offset:3072
Lred_130:
    v_mov_b32 v12, 0
    v_mov_b32 v56, 0
    v_mov_b32 v28, 0
    v_mov_b32 v13, 0
    v_mov_b32 v57, 0
    v_mov_b32 v29, 0
    v_mov_b32 v14, 0
    v_mov_b32 v58, 0
    v_mov_b32 v30, 0
    v_mov_b32 v15, 0
    v_mov_b32 v59, 0
    v_mov_b32 v31, 0
    v_mov_b32 v16, 0
    v_mov_b32 v60, 0
    v_mov_b32 v32, 0
    v_mov_b32 v17, 0
    v_mov_b32 v61, 0
    v_mov_b32 v33, 0
    v_mov_b32 v18, 0
    v_mov_b32 v62, 0
    v_mov_b32 v34, 0
    v_mov_b32 v19, 0
    v_mov_b32 v63, 0
    v_mov_b32 v35, 0
    s_barrier
    s_add_u32 s18, s18, 1
    s_branch LstepA_100
Lfin_91:
    s_waitcnt vmcnt(0)
    s_barrier
    s_cmp_lg_u32 s10, 0
    s_cbranch_scc1 Lend_1
    s_mov_b64 exec, 1
    v_mov_b32 v0, s101
    v_mov_b32 v1, 64
    global_store_dword v0, v1, s[4:5] sc1
Lend_1:
    s_endpgm
.section .rodata,"a"
.p2align 6
.amdhsa_kernel mega_kernel
  .amdhsa_next_free_vgpr 512
  .amdhsa_next_free_sgpr 102
  .amdhsa_accum_offset 256
  .amdhsa_group_segment_fixed_size 0
  .amdhsa_kernarg_size 112
  .amdhsa_user_sgpr_count 2
  .amdhsa_user_sgpr_kernarg_segment_ptr 1
  .amdhsa_system_sgpr_workgroup_id_x 1
.end_amdhsa_kernel
```
